```python
import torch

def _softmax(x, axis=-1):
    return torch.softmax(x, dim=axis)
def _gelu(x):
    return torch.nn.functional.gelu(x, approximate="tanh")
def _silu(x):
    return torch.nn.functional.silu(x)
def _sigmoid(x):
    return torch.sigmoid(x)
def _layernorm(x, axis=-1, eps=1e-5):
    m = x.mean(dim=axis, keepdim=True)
    v = x.var(dim=axis, keepdim=True, unbiased=False)
    return (x - m) / torch.sqrt(v + eps)
def _scatter_add(tgt, idx, src, axis=0):
    return tgt.clone().index_add_(axis, idx, src)
def _segment_sum(src, seg, n):
    out = torch.zeros((n,) + src.shape[1:], dtype=src.dtype)
    return out.index_add_(0, seg, src)
def _pad(x, pw):
    flat = tuple(v for pair in reversed(pw) for v in pair)
    return torch.nn.functional.pad(x, flat)

kernel_name = 'concat_heads__gqa_block_cached__mha_block_cached__near_ridge'

def setup_inputs():

    _w = (lambda a: (lambda t: t.to(torch.bfloat16) if t.is_floating_point() else t)(torch.as_tensor(a)))
    def _A_setup():
        B, Sq, D = 32, 32, 1024
        Hq, Hkv, Sk, Dh = 32, 4, 512, 128
        assert Hq % Hkv == 0, (Hq, Hkv)
        return {
            "x": _w((lambda *s: torch.randn(*s, dtype=torch.bfloat16) * 0.8)(B, Sq, D)),
            "k_cache": _w((lambda *s: torch.randn(*s, dtype=torch.bfloat16) * 0.8)(B, Hkv, Sk, Dh)),
            "v_cache": _w((lambda *s: torch.randn(*s, dtype=torch.bfloat16) * 0.05)(B, Hkv, Sk, Dh)),
            "wq": _w((lambda *s: torch.randn(*s, dtype=torch.bfloat16) * 0.8)(D, Hq * Dh) * (D ** -0.5)),
            "wo": _w((lambda *s: torch.randn(*s, dtype=torch.bfloat16) * 0.05)(Hq * Dh, D) * ((Hq * Dh) ** -0.5)),
        }
    _A_in = _A_setup()

    def _B_setup():
        B, Sq, D = 32, 32, 1024
        H, Sk, Dh = 32, 512, 128
        return {
            "x": _w((lambda *s: torch.randn(*s, dtype=torch.bfloat16) * 0.8)(B, Sq, D)),
            "k_cache": _w((lambda *s: torch.randn(*s, dtype=torch.bfloat16) * 0.8)(B, H, Sk, Dh)),
            "v_cache": _w((lambda *s: torch.randn(*s, dtype=torch.bfloat16) * 0.05)(B, H, Sk, Dh)),
            "wq": _w((lambda *s: torch.randn(*s, dtype=torch.bfloat16) * 0.8)(D, H * Dh) * (D ** -0.5)),
            "wo": _w((lambda *s: torch.randn(*s, dtype=torch.bfloat16) * 0.05)(H * Dh, D) * ((H * Dh) ** -0.5)),
        }
    _B_in = _B_setup()

    return {
        "A_x": _A_in["x"],
        "A_k_cache": _A_in["k_cache"],
        "A_v_cache": _A_in["v_cache"],
        "A_wq": _A_in["wq"],
        "A_wo": _A_in["wo"],
        "B_x": _B_in["x"],
        "B_k_cache": _B_in["k_cache"],
        "B_v_cache": _B_in["v_cache"],
        "B_wq": _B_in["wq"],
        "B_wo": _B_in["wo"],
    }

def reference(A_x, A_k_cache, A_v_cache, A_wq, A_wo, B_x, B_k_cache, B_v_cache, B_wq, B_wo):
    def _A_ref(x, k_cache, v_cache, wq, wo):
        B, Sq, D = x.shape
        Hq, Dh = 32, 128
        Hkv = k_cache.shape[1]
        rep = Hq // Hkv
        q = (lambda x, *d: x.permute(*d))((x @ wq).reshape(B, Sq, Hq, Dh), 0, 2, 1, 3)
        k = (lambda x, n, axis: torch.repeat_interleave(x, n, dim=axis))(k_cache, rep, axis=1)
        v = (lambda x, n, axis: torch.repeat_interleave(x, n, dim=axis))(v_cache, rep, axis=1)
        scores = torch.einsum("bhqd,bhkd->bhqk", q, k) * (Dh ** -0.5)
        p = _softmax(scores, axis=-1)
        o = torch.einsum("bhqk,bhkd->bhqd", p, v)
        return (lambda x, *d: x.permute(*d))(o, 0, 2, 1, 3).reshape(B, Sq, Hq * Dh) @ wo

    def _B_ref(x, k_cache, v_cache, wq, wo):
        B, Sq, D = x.shape
        H, Dh = 32, 128
        q = (lambda x, *d: x.permute(*d))((x @ wq).reshape(B, Sq, H, Dh), 0, 2, 1, 3)
        scores = torch.einsum("bhqd,bhkd->bhqk", q, k_cache) * (Dh ** -0.5)
        p = _softmax(scores, axis=-1)
        o = torch.einsum("bhqk,bhkd->bhqd", p, v_cache)
        return (lambda x, *d: x.permute(*d))(o, 0, 2, 1, 3).reshape(B, Sq, H * Dh) @ wo

    a = _A_ref(A_x, A_k_cache, A_v_cache, A_wq, A_wo)
    b = _B_ref(B_x, B_k_cache, B_v_cache, B_wq, B_wo)
    return torch.concatenate([a, b], axis=-1)
```

```asm
; @launch grid=(512,1,1) block=(256,1,1) lds=81920
.amdgcn_target "amdgcn-amd-amdhsa--gfx950"
.text
.globl concat_heads__gqa_block_cached__mha_block_cached__near_ridge_kernel
.p2align 8
.type concat_heads__gqa_block_cached__mha_block_cached__near_ridge_kernel,@function
concat_heads__gqa_block_cached__mha_block_cached__near_ridge_kernel:
  s_cmp_ge_u32 s2, 512
  s_cbranch_scc1 L_qa_end
  s_load_dwordx8 s[44:51], s[0:1], 0
  s_load_dwordx8 s[52:59], s[0:1], 40
  s_load_dwordx2 s[60:61], s[0:1], 96
  s_load_dwordx2 s[80:81], s[0:1], 88
  v_lshrrev_b32 v1, 6, v0
s_nop 0
  v_readfirstlane_b32 s4, v1
  v_and_b32 v0, 63, v0
  s_lshr_b32 s7, s2, 8
  s_and_b32 s3, s2, 255
  s_and_b32 s34, s3, 7
  s_lshr_b32 s35, s3, 3
  s_lshr_b32 s36, s34, 1
  s_lshl_b32 s36, s36, 3
  s_and_b32 s37, s35, 7
  s_add_u32 s62, s36, s37
  s_and_b32 s36, s34, 1
  s_lshl_b32 s36, s36, 2
  s_lshr_b32 s37, s35, 3
  s_add_u32 s63, s36, s37
  s_lshl_b32 s64, s63, 2
  s_add_u32 s64, s64, s4
  s_and_b32 s65, s63, 3
  s_lshl_b32 s65, s65, 1
  s_and_b32 s36, s62, 7
  s_add_u32 s65, s65, s36
  s_and_b32 s65, s65, 7
  s_lshr_b32 s36, s34, 1
  s_lshl_b32 s36, s36, 2
  s_and_b32 s37, s35, 3
  s_add_u32 s79, s36, s37
  s_and_b32 s36, s34, 1
  s_lshl_b32 s36, s36, 3
  s_lshr_b32 s37, s35, 2
  s_add_u32 s66, s36, s37
  s_and_b32 s77, s4, 1
  s_lshr_b32 s78, s4, 1
  s_lshl_b32 s67, s79, 1
  s_lshl_b32 s68, s66, 1
  s_add_u32 s69, s67, s77
  s_add_u32 s70, s68, s78
  s_and_b32 s71, s79, 3
  s_lshl_b32 s71, s71, 1
  s_and_b32 s36, s66, 7
  s_add_u32 s71, s71, s36
  s_and_b32 s71, s71, 7
  s_cmp_eq_u32 s7, 0
  s_cselect_b32 s5, s62, s69
  s_cselect_b32 s6, s64, s70
  s_cselect_b32 s75, s62, s67
  s_cselect_b32 s76, s64, s68
  s_cselect_b32 s74, s65, s71
  s_lshl_b32 s36, s4, 12
  s_lshl_b32 s37, s78, 13
  s_cmp_eq_u32 s7, 0
  s_cselect_b32 s41, s36, s37
  s_cselect_b32 s88, 14, 12
  s_lshl_b32 s36, s4, 12
  s_lshl_b32 s37, s78, 12
  s_add_u32 s37, s37, 65536
  s_cmp_eq_u32 s7, 0
  s_cselect_b32 s82, s36, s37
  s_lshl_b32 s36, s77, 13
  s_cmp_eq_u32 s7, 0
  s_cselect_b32 s83, 49152, s36
  v_and_b32 v1, 15, v0
  v_lshrrev_b32 v2, 4, v0
  v_and_b32 v3, 31, v0
  v_lshrrev_b32 v4, 5, v0
  v_xor_b32 v5, v1, v2
  v_lshlrev_b32 v5, 4, v5
  v_lshl_add_u32 v8, v2, 8, v5
  v_xor_b32 v9, 64, v8
  v_xor_b32 v10, 128, v8
  v_xor_b32 v11, 192, v8
  v_lshlrev_b32 v5, 2, v2
  v_xor_b32 v5, v1, v5
  v_lshlrev_b32 v5, 4, v5
  v_lshl_add_u32 v12, v2, 8, v5
  v_lshl_add_u32 v13, v2, 13, v5
  v_and_b32 v5, 7, v0
  v_xor_b32 v5, v5, v2
  v_lshlrev_b32 v5, 4, v5
  v_lshrrev_b32 v6, 3, v0
  v_lshl_add_u32 v14, v6, 11, v5
  v_xor_b32 v15, 64, v14
  v_xor_b32 v5, v4, v1
  v_lshlrev_b32 v5, 4, v5
  v_lshl_add_u32 v5, v1, 8, v5
  v_lshrrev_b32 v6, 4, v3
  v_lshlrev_b32 v6, s88, v6
  v_add_u32 v5, v5, v6
  v_add_u32 v5, s41, v5
  v_mov_b32 v16, v5
  v_xor_b32 v17, 32, v5
  v_xor_b32 v18, 64, v5
  v_xor_b32 v19, 96, v5
  v_xor_b32 v20, 128, v5
  v_xor_b32 v21, 160, v5
  v_xor_b32 v22, 192, v5
  v_xor_b32 v23, 224, v5
  v_lshrrev_b32 v6, 2, v0
  v_and_b32 v6, 3, v6
  v_and_b32 v7, 3, v0
  v_lshl_add_u32 v5, v4, 2, v6
  v_lshlrev_b32 v5, 8, v5
  v_and_b32 v1, 1, v2
  v_lshl_add_u32 v5, v1, 5, v5
  v_lshl_add_u32 v5, v7, 3, v5
  v_add_u32 v37, s41, v5
  v_lshlrev_b32 v3, 6, v6
  v_xor_b32 v1, 0, v3
  v_add_u32 v24, v37, v1
  v_xor_b32 v1, 64, v3
  v_add_u32 v25, v37, v1
  v_xor_b32 v1, 128, v3
  v_add_u32 v26, v37, v1
  v_xor_b32 v1, 192, v3
  v_add_u32 v27, v37, v1
  v_lshl_add_u32 v5, v4, 3, v6
  v_lshlrev_b32 v5, 8, v5
  v_and_b32 v1, 1, v2
  v_lshl_add_u32 v5, v1, 5, v5
  v_and_b32 v1, 1, v7
  v_lshlrev_b32 v1, 4, v1
  v_lshrrev_b32 v7, 1, v7
  v_lshl_add_u32 v1, v7, 3, v1
  v_add_u32 v5, v5, v1
  v_add_u32 v5, s83, v5
  v_xor_b32 v1, 0, v3
  v_add_u32 v28, v5, v1
  v_xor_b32 v1, 64, v3
  v_add_u32 v29, v5, v1
  v_xor_b32 v1, 128, v3
  v_add_u32 v30, v5, v1
  v_xor_b32 v1, 192, v3
  v_add_u32 v31, v5, v1
  v_and_b32 v5, 31, v0
  v_lshrrev_b32 v6, 1, v5
  v_and_b32 v6, 7, v6
  v_xor_b32 v6, v6, v4
  v_lshlrev_b32 v6, 4, v6
  v_lshl_add_u32 v5, v5, 7, v6
  v_add_u32 v5, s82, v5
  v_xor_b32 v240, 0, v5
  v_xor_b32 v241, 32, v5
  v_xor_b32 v242, 64, v5
  v_xor_b32 v243, 96, v5
  s_waitcnt lgkmcnt(0)
  s_cmp_eq_u32 s7, 0
  s_cselect_b32 s62, s52, s44
  s_cselect_b32 s63, s53, s45
  s_cselect_b32 s64, s54, s46
  s_cselect_b32 s65, s55, s47
  s_cselect_b32 s66, s56, s48
  s_cselect_b32 s67, s57, s49
  s_cselect_b32 s68, s58, s50
  s_cselect_b32 s69, s59, s51
  s_lshl_b32 s34, s6, 5
  s_add_u32 s34, s34, s5
  s_lshl_b32 s35, s6, 2
  s_lshr_b32 s36, s5, 3
  s_add_u32 s35, s35, s36
  s_cmp_eq_u32 s7, 0
  s_cselect_b32 s34, s34, s35
  s_mul_i32 s33, s34, 5
  s_lshr_b32 s35, s34, 4
  s_add_u32 s33, s33, s35
  s_and_b32 s72, s33, 3
  s_lshl_b32 s72, s72, 15
  s_lshr_b32 s33, s33, 2
  s_and_b32 s35, s79, 3
  s_lshl_b32 s35, s35, 1
  s_cmp_eq_u32 s7, 0
  s_cselect_b32 s35, 0, s35
  s_add_u32 s33, s33, s35
  s_and_b32 s33, s33, 7
  s_lshl_b32 s33, s33, 12
  s_add_u32 s73, s72, 32768
  s_and_b32 s73, s73, 0x18000
  s_lshl_b32 s35, s34, 17
  s_add_u32 s64, s64, s35
  s_addc_u32 s65, s65, 0
  s_add_u32 s66, s66, s35
  s_addc_u32 s67, s67, 0
  s_mov_b32 s16, s64
  s_and_b32 s17, s65, 0xffff
  s_mov_b32 s18, 131072
  s_mov_b32 s19, 0x20000
  s_mov_b32 s20, s66
  s_and_b32 s21, s67, 0xffff
  s_mov_b32 s22, 131072
  s_mov_b32 s23, 0x20000
  s_and_b32 s35, s6, 0xfffffffc
  s_cmp_eq_u32 s7, 0
  s_cselect_b32 s35, s35, s76
  s_lshl_b32 s35, s35, 16
  s_add_u32 s38, s62, s35
  s_addc_u32 s39, s63, 0
  s_lshl_b32 s35, s76, 16
  s_add_u32 s62, s62, s35
  s_addc_u32 s63, s63, 0
  s_cmp_eq_u32 s7, 0
  s_cselect_b32 s36, 1, 2
  s_lshl_b32 s36, s36, 16
  s_mov_b32 s12, s62
  s_and_b32 s13, s63, 0xffff
  s_mov_b32 s14, s36
  s_mov_b32 s15, 0x20000
  s_lshl_b32 s35, s75, 8
  s_add_u32 s68, s68, s35
  s_addc_u32 s69, s69, 0
  s_sub_u32 s36, 8388608, s35
  s_mov_b32 s8, s68
  s_and_b32 s9, s69, 0xffff
  s_mov_b32 s10, s36
  s_mov_b32 s11, 0x20000
  s_lshl_b32 s35, s6, 18
  s_lshl_b32 s36, s5, 13
  s_add_u32 s35, s35, s36
  s_cmp_eq_u32 s7, 0
  s_cselect_b32 s36, 8388608, 0
  s_add_u32 s35, s35, s36
  s_add_u32 s70, s60, s35
  s_addc_u32 s71, s61, 0
  s_mov_b32 s24, s70
  s_and_b32 s25, s71, 0xffff
  s_mov_b32 s26, 8192
  s_mov_b32 s27, 0x20000
  s_mov_b32 s40, 0x3e0293ee
  s_cmp_eq_u32 s7, 0
  s_cbranch_scc0 L_roleA
  s_add_u32 s94, s60, 26214400
  s_addc_u32 s95, s61, 0
  s_lshl_b32 s34, s2, 7
  v_mov_b32 v248, s34
  v_mov_b32 v249, 0
  s_cmp_lg_u32 s4, 0
  s_cbranch_scc1 L_rst
  s_mov_b64 s[96:97], exec
  s_mov_b64 exec, 1
  global_store_dword v248, v249, s[94:95] sc1
  s_mov_b64 exec, s[96:97]
L_rst:
  s_lshr_b32 s74, s74, 1
  s_lshl_b32 s86, s4, 16
  s_mov_b32 s87, 0
  s_lshl_b32 s84, s4, 11
  s_lshl_b32 s85, s4, 12
  s_mov_b32 s43, -1
  s_mov_b32 s31, -1
  s_add_u32 s43, s43, 1
  s_add_u32 s34, s43, s74
  s_and_b32 s34, s34, 3
  s_and_b32 s36, s43, 252
  s_or_b32 s34, s34, s36
  s_lshl_b32 s34, s34, 19
  s_add_u32 s29, s34, s86
  s_add_u32 m0, s84, 49152
  s_add_u32 s35, s29, 0
  buffer_load_dwordx4 v13, s[8:11], s35 offen  lds
  s_add_u32 m0, s84, 50176
  s_add_u32 s35, s29, 32768
  buffer_load_dwordx4 v13, s[8:11], s35 offen  lds
  s_add_u32 s31, s31, 1
  s_add_u32 s34, s31, s74
  s_and_b32 s34, s34, 3
  s_and_b32 s36, s31, 252
  s_or_b32 s34, s34, s36
  s_lshl_b32 s34, s34, 7
  s_add_u32 s30, s34, s87
  s_add_u32 m0, s85, 0
  s_add_u32 s35, s30, 0
  buffer_load_dwordx4 v14, s[12:15], s35 offen  lds
  s_add_u32 m0, s85, 1024
  s_add_u32 s35, s30, 16384
  buffer_load_dwordx4 v15, s[12:15], s35 offen  lds
  s_add_u32 m0, s85, 2048
  s_add_u32 s35, s30, 32768
  buffer_load_dwordx4 v14, s[12:15], s35 offen  lds
  s_add_u32 m0, s85, 3072
  s_add_u32 s35, s30, 49152
  buffer_load_dwordx4 v15, s[12:15], s35 offen  lds
  s_add_u32 m0, s84, 57344
  s_add_u32 s35, s29, 262144
  buffer_load_dwordx4 v13, s[8:11], s35 offen  lds
  s_add_u32 m0, s84, 58368
  s_add_u32 s35, s29, 294912
  buffer_load_dwordx4 v13, s[8:11], s35 offen  lds
  s_add_u32 s43, s43, 1
  s_add_u32 s34, s43, s74
  s_and_b32 s34, s34, 3
  s_and_b32 s36, s43, 252
  s_or_b32 s34, s34, s36
  s_lshl_b32 s34, s34, 19
  s_add_u32 s29, s34, s86
  s_add_u32 m0, s84, 65536
  s_add_u32 s35, s29, 0
  buffer_load_dwordx4 v13, s[8:11], s35 offen  lds
  s_add_u32 m0, s84, 66560
  s_add_u32 s35, s29, 32768
  buffer_load_dwordx4 v13, s[8:11], s35 offen  lds
  s_add_u32 s31, s31, 1
  s_add_u32 s34, s31, s74
  s_and_b32 s34, s34, 3
  s_and_b32 s36, s31, 252
  s_or_b32 s34, s34, s36
  s_lshl_b32 s34, s34, 7
  s_add_u32 s30, s34, s87
  s_add_u32 m0, s85, 32768
  s_add_u32 s35, s30, 0
  buffer_load_dwordx4 v14, s[12:15], s35 offen  lds
  s_add_u32 m0, s85, 33792
  s_add_u32 s35, s30, 16384
  buffer_load_dwordx4 v15, s[12:15], s35 offen  lds
  s_add_u32 m0, s85, 34816
  s_add_u32 s35, s30, 32768
  buffer_load_dwordx4 v14, s[12:15], s35 offen  lds
  s_add_u32 m0, s85, 35840
  s_add_u32 s35, s30, 49152
  buffer_load_dwordx4 v15, s[12:15], s35 offen  lds
  s_add_u32 m0, s84, 73728
  s_add_u32 s35, s29, 262144
  buffer_load_dwordx4 v13, s[8:11], s35 offen  lds
  s_add_u32 m0, s84, 74752
  s_add_u32 s35, s29, 294912
  buffer_load_dwordx4 v13, s[8:11], s35 offen  lds
  v_mov_b32 v72, 0
  v_mov_b32 v73, 0
  v_mov_b32 v74, 0
  v_mov_b32 v75, 0
  v_mov_b32 v76, 0
  v_mov_b32 v77, 0
  v_mov_b32 v78, 0
  v_mov_b32 v79, 0
  v_mov_b32 v80, 0
  v_mov_b32 v81, 0
  v_mov_b32 v82, 0
  v_mov_b32 v83, 0
  v_mov_b32 v84, 0
  v_mov_b32 v85, 0
  v_mov_b32 v86, 0
  v_mov_b32 v87, 0
  v_mov_b32 v88, 0
  v_mov_b32 v89, 0
  v_mov_b32 v90, 0
  v_mov_b32 v91, 0
  v_mov_b32 v92, 0
  v_mov_b32 v93, 0
  v_mov_b32 v94, 0
  v_mov_b32 v95, 0
  v_mov_b32 v96, 0
  v_mov_b32 v97, 0
  v_mov_b32 v98, 0
  v_mov_b32 v99, 0
  v_mov_b32 v100, 0
  v_mov_b32 v101, 0
  v_mov_b32 v102, 0
  v_mov_b32 v103, 0
  v_mov_b32 v104, 0
  v_mov_b32 v105, 0
  v_mov_b32 v106, 0
  v_mov_b32 v107, 0
  v_mov_b32 v108, 0
  v_mov_b32 v109, 0
  v_mov_b32 v110, 0
  v_mov_b32 v111, 0
  v_mov_b32 v112, 0
  v_mov_b32 v113, 0
  v_mov_b32 v114, 0
  v_mov_b32 v115, 0
  v_mov_b32 v116, 0
  v_mov_b32 v117, 0
  v_mov_b32 v118, 0
  v_mov_b32 v119, 0
  v_mov_b32 v120, 0
  v_mov_b32 v121, 0
  v_mov_b32 v122, 0
  v_mov_b32 v123, 0
  v_mov_b32 v124, 0
  v_mov_b32 v125, 0
  v_mov_b32 v126, 0
  v_mov_b32 v127, 0
  v_mov_b32 v128, 0
  v_mov_b32 v129, 0
  v_mov_b32 v130, 0
  v_mov_b32 v131, 0
  v_mov_b32 v132, 0
  v_mov_b32 v133, 0
  v_mov_b32 v134, 0
  v_mov_b32 v135, 0
  s_waitcnt vmcnt(10)
  s_barrier
  ds_read_b128 v[232:235], v240 offset:0
  ds_read_b64_tr_b16 v[200:201], v28 offset:0
  ds_read_b64_tr_b16 v[202:203], v28 offset:1024
  ds_read_b64_tr_b16 v[204:205], v29 offset:0
  ds_read_b64_tr_b16 v[206:207], v29 offset:1024
  ds_read_b64_tr_b16 v[208:209], v30 offset:0
  ds_read_b64_tr_b16 v[210:211], v30 offset:1024
  ds_read_b64_tr_b16 v[212:213], v31 offset:0
  ds_read_b64_tr_b16 v[214:215], v31 offset:1024
  ds_read_b128 v[236:239], v241 offset:0
  s_mov_b32 s28, 6
L_q_B:
  s_waitcnt lgkmcnt(7)
  v_mfma_f32_32x32x16_bf16 v[72:87], v[200:203], v[232:235], v[72:87]
  ds_read_b64_tr_b16 v[216:217], v28 offset:4096
  ds_read_b64_tr_b16 v[218:219], v28 offset:5120
  ds_read_b64_tr_b16 v[220:221], v29 offset:4096
  ds_read_b64_tr_b16 v[222:223], v29 offset:5120
  s_waitcnt lgkmcnt(9)
  v_mfma_f32_32x32x16_bf16 v[88:103], v[204:207], v[232:235], v[88:103]
  ds_read_b64_tr_b16 v[224:225], v30 offset:4096
  ds_read_b64_tr_b16 v[226:227], v30 offset:5120
  ds_read_b64_tr_b16 v[228:229], v31 offset:4096
  ds_read_b64_tr_b16 v[230:231], v31 offset:5120
  s_waitcnt lgkmcnt(11)
  v_mfma_f32_32x32x16_bf16 v[104:119], v[208:211], v[232:235], v[104:119]
  s_add_u32 s43, s43, 1
  s_add_u32 s34, s43, s74
  s_and_b32 s34, s34, 3
  s_and_b32 s36, s43, 252
  s_or_b32 s34, s34, s36
  s_lshl_b32 s34, s34, 19
  s_add_u32 s29, s34, s86
  s_waitcnt lgkmcnt(9)
  v_mfma_f32_32x32x16_bf16 v[120:135], v[212:215], v[232:235], v[120:135]
  s_waitcnt vmcnt(8) lgkmcnt(0)
  s_barrier
  v_mfma_f32_32x32x16_bf16 v[72:87], v[216:219], v[236:239], v[72:87]
  ds_read_b128 v[168:171], v242 offset:0
  ds_read_b64_tr_b16 v[136:137], v28 offset:8192
  ds_read_b64_tr_b16 v[138:139], v28 offset:9216
  s_add_u32 m0, s84, 49152
  s_add_u32 s35, s29, 0
  buffer_load_dwordx4 v13, s[8:11], s35 offen  lds
  v_mfma_f32_32x32x16_bf16 v[88:103], v[220:223], v[236:239], v[88:103]
  ds_read_b64_tr_b16 v[140:141], v29 offset:8192
  ds_read_b64_tr_b16 v[142:143], v29 offset:9216
  ds_read_b64_tr_b16 v[144:145], v30 offset:8192
  s_add_u32 m0, s84, 50176
  s_add_u32 s35, s29, 32768
  buffer_load_dwordx4 v13, s[8:11], s35 offen  lds
  v_mfma_f32_32x32x16_bf16 v[104:119], v[224:227], v[236:239], v[104:119]
  ds_read_b64_tr_b16 v[146:147], v30 offset:9216
  ds_read_b64_tr_b16 v[148:149], v31 offset:8192
  v_mfma_f32_32x32x16_bf16 v[120:135], v[228:231], v[236:239], v[120:135]
  ds_read_b64_tr_b16 v[150:151], v31 offset:9216
  ds_read_b128 v[172:175], v243 offset:0
  s_waitcnt lgkmcnt(7)
  v_mfma_f32_32x32x16_bf16 v[72:87], v[136:139], v[168:171], v[72:87]
  ds_read_b64_tr_b16 v[152:153], v28 offset:12288
  ds_read_b64_tr_b16 v[154:155], v28 offset:13312
  ds_read_b64_tr_b16 v[156:157], v29 offset:12288
  ds_read_b64_tr_b16 v[158:159], v29 offset:13312
  s_waitcnt lgkmcnt(9)
  v_mfma_f32_32x32x16_bf16 v[88:103], v[140:143], v[168:171], v[88:103]
  ds_read_b64_tr_b16 v[160:161], v30 offset:12288
  ds_read_b64_tr_b16 v[162:163], v30 offset:13312
  ds_read_b64_tr_b16 v[164:165], v31 offset:12288
  ds_read_b64_tr_b16 v[166:167], v31 offset:13312
  s_waitcnt lgkmcnt(11)
  v_mfma_f32_32x32x16_bf16 v[104:119], v[144:147], v[168:171], v[104:119]
  s_add_u32 s31, s31, 1
  s_add_u32 s34, s31, s74
  s_and_b32 s34, s34, 3
  s_and_b32 s36, s31, 252
  s_or_b32 s34, s34, s36
  s_lshl_b32 s34, s34, 7
  s_add_u32 s30, s34, s87
  s_waitcnt lgkmcnt(9)
  v_mfma_f32_32x32x16_bf16 v[120:135], v[148:151], v[168:171], v[120:135]
  s_waitcnt vmcnt(4) lgkmcnt(0)
  s_barrier
  v_mfma_f32_32x32x16_bf16 v[72:87], v[152:155], v[172:175], v[72:87]
  ds_read_b128 v[232:235], v240 offset:32768
  ds_read_b64_tr_b16 v[200:201], v28 offset:16384
  ds_read_b64_tr_b16 v[202:203], v28 offset:17408
  s_add_u32 m0, s85, 0
  s_add_u32 s35, s30, 0
  buffer_load_dwordx4 v14, s[12:15], s35 offen  lds
  s_add_u32 m0, s85, 1024
  s_add_u32 s35, s30, 16384
  buffer_load_dwordx4 v15, s[12:15], s35 offen  lds
  v_mfma_f32_32x32x16_bf16 v[88:103], v[156:159], v[172:175], v[88:103]
  ds_read_b64_tr_b16 v[204:205], v29 offset:16384
  ds_read_b64_tr_b16 v[206:207], v29 offset:17408
  ds_read_b64_tr_b16 v[208:209], v30 offset:16384
  s_add_u32 m0, s85, 2048
  s_add_u32 s35, s30, 32768
  buffer_load_dwordx4 v14, s[12:15], s35 offen  lds
  s_add_u32 m0, s85, 3072
  s_add_u32 s35, s30, 49152
  buffer_load_dwordx4 v15, s[12:15], s35 offen  lds
  v_mfma_f32_32x32x16_bf16 v[104:119], v[160:163], v[172:175], v[104:119]
  ds_read_b64_tr_b16 v[210:211], v30 offset:17408
  ds_read_b64_tr_b16 v[212:213], v31 offset:16384
  s_add_u32 m0, s84, 57344
  s_add_u32 s35, s29, 262144
  buffer_load_dwordx4 v13, s[8:11], s35 offen  lds
  v_mfma_f32_32x32x16_bf16 v[120:135], v[164:167], v[172:175], v[120:135]
  ds_read_b64_tr_b16 v[214:215], v31 offset:17408
  ds_read_b128 v[236:239], v241 offset:32768
  s_add_u32 m0, s84, 58368
  s_add_u32 s35, s29, 294912
  buffer_load_dwordx4 v13, s[8:11], s35 offen  lds
  s_waitcnt lgkmcnt(7)
  v_mfma_f32_32x32x16_bf16 v[72:87], v[200:203], v[232:235], v[72:87]
  ds_read_b64_tr_b16 v[216:217], v28 offset:20480
  ds_read_b64_tr_b16 v[218:219], v28 offset:21504
  ds_read_b64_tr_b16 v[220:221], v29 offset:20480
  ds_read_b64_tr_b16 v[222:223], v29 offset:21504
  s_waitcnt lgkmcnt(9)
  v_mfma_f32_32x32x16_bf16 v[88:103], v[204:207], v[232:235], v[88:103]
  ds_read_b64_tr_b16 v[224:225], v30 offset:20480
  ds_read_b64_tr_b16 v[226:227], v30 offset:21504
  ds_read_b64_tr_b16 v[228:229], v31 offset:20480
  ds_read_b64_tr_b16 v[230:231], v31 offset:21504
  s_waitcnt lgkmcnt(11)
  v_mfma_f32_32x32x16_bf16 v[104:119], v[208:211], v[232:235], v[104:119]
  s_add_u32 s43, s43, 1
  s_add_u32 s34, s43, s74
  s_and_b32 s34, s34, 3
  s_and_b32 s36, s43, 252
  s_or_b32 s34, s34, s36
  s_lshl_b32 s34, s34, 19
  s_add_u32 s29, s34, s86
  s_waitcnt lgkmcnt(9)
  v_mfma_f32_32x32x16_bf16 v[120:135], v[212:215], v[232:235], v[120:135]
  s_waitcnt vmcnt(8) lgkmcnt(0)
  s_barrier
  v_mfma_f32_32x32x16_bf16 v[72:87], v[216:219], v[236:239], v[72:87]
  ds_read_b128 v[168:171], v242 offset:32768
  ds_read_b64_tr_b16 v[136:137], v28 offset:24576
  ds_read_b64_tr_b16 v[138:139], v28 offset:25600
  s_add_u32 m0, s84, 65536
  s_add_u32 s35, s29, 0
  buffer_load_dwordx4 v13, s[8:11], s35 offen  lds
  v_mfma_f32_32x32x16_bf16 v[88:103], v[220:223], v[236:239], v[88:103]
  ds_read_b64_tr_b16 v[140:141], v29 offset:24576
  ds_read_b64_tr_b16 v[142:143], v29 offset:25600
  ds_read_b64_tr_b16 v[144:145], v30 offset:24576
  s_add_u32 m0, s84, 66560
  s_add_u32 s35, s29, 32768
  buffer_load_dwordx4 v13, s[8:11], s35 offen  lds
  v_mfma_f32_32x32x16_bf16 v[104:119], v[224:227], v[236:239], v[104:119]
  ds_read_b64_tr_b16 v[146:147], v30 offset:25600
  ds_read_b64_tr_b16 v[148:149], v31 offset:24576
  v_mfma_f32_32x32x16_bf16 v[120:135], v[228:231], v[236:239], v[120:135]
  ds_read_b64_tr_b16 v[150:151], v31 offset:25600
  ds_read_b128 v[172:175], v243 offset:32768
  s_waitcnt lgkmcnt(7)
  v_mfma_f32_32x32x16_bf16 v[72:87], v[136:139], v[168:171], v[72:87]
  ds_read_b64_tr_b16 v[152:153], v28 offset:28672
  ds_read_b64_tr_b16 v[154:155], v28 offset:29696
  ds_read_b64_tr_b16 v[156:157], v29 offset:28672
  ds_read_b64_tr_b16 v[158:159], v29 offset:29696
  s_waitcnt lgkmcnt(9)
  v_mfma_f32_32x32x16_bf16 v[88:103], v[140:143], v[168:171], v[88:103]
  ds_read_b64_tr_b16 v[160:161], v30 offset:28672
  ds_read_b64_tr_b16 v[162:163], v30 offset:29696
  ds_read_b64_tr_b16 v[164:165], v31 offset:28672
  ds_read_b64_tr_b16 v[166:167], v31 offset:29696
  s_waitcnt lgkmcnt(11)
  v_mfma_f32_32x32x16_bf16 v[104:119], v[144:147], v[168:171], v[104:119]
  s_add_u32 s31, s31, 1
  s_add_u32 s34, s31, s74
  s_and_b32 s34, s34, 3
  s_and_b32 s36, s31, 252
  s_or_b32 s34, s34, s36
  s_lshl_b32 s34, s34, 7
  s_add_u32 s30, s34, s87
  s_waitcnt lgkmcnt(9)
  v_mfma_f32_32x32x16_bf16 v[120:135], v[148:151], v[168:171], v[120:135]
  s_waitcnt vmcnt(4) lgkmcnt(0)
  s_barrier
  v_mfma_f32_32x32x16_bf16 v[72:87], v[152:155], v[172:175], v[72:87]
  ds_read_b128 v[232:235], v240 offset:0
  ds_read_b64_tr_b16 v[200:201], v28 offset:0
  ds_read_b64_tr_b16 v[202:203], v28 offset:1024
  s_add_u32 m0, s85, 32768
  s_add_u32 s35, s30, 0
  buffer_load_dwordx4 v14, s[12:15], s35 offen  lds
  s_add_u32 m0, s85, 33792
  s_add_u32 s35, s30, 16384
  buffer_load_dwordx4 v15, s[12:15], s35 offen  lds
  v_mfma_f32_32x32x16_bf16 v[88:103], v[156:159], v[172:175], v[88:103]
  ds_read_b64_tr_b16 v[204:205], v29 offset:0
  ds_read_b64_tr_b16 v[206:207], v29 offset:1024
  ds_read_b64_tr_b16 v[208:209], v30 offset:0
  s_add_u32 m0, s85, 34816
  s_add_u32 s35, s30, 32768
  buffer_load_dwordx4 v14, s[12:15], s35 offen  lds
  s_add_u32 m0, s85, 35840
  s_add_u32 s35, s30, 49152
  buffer_load_dwordx4 v15, s[12:15], s35 offen  lds
  v_mfma_f32_32x32x16_bf16 v[104:119], v[160:163], v[172:175], v[104:119]
  ds_read_b64_tr_b16 v[210:211], v30 offset:1024
  ds_read_b64_tr_b16 v[212:213], v31 offset:0
  s_add_u32 m0, s84, 73728
  s_add_u32 s35, s29, 262144
  buffer_load_dwordx4 v13, s[8:11], s35 offen  lds
  v_mfma_f32_32x32x16_bf16 v[120:135], v[164:167], v[172:175], v[120:135]
  ds_read_b64_tr_b16 v[214:215], v31 offset:1024
  ds_read_b128 v[236:239], v241 offset:0
  s_add_u32 m0, s84, 74752
  s_add_u32 s35, s29, 294912
  buffer_load_dwordx4 v13, s[8:11], s35 offen  lds
  s_sub_u32 s28, s28, 1
  s_cmp_lg_u32 s28, 0
  s_cbranch_scc1 L_q_B
  s_waitcnt lgkmcnt(7)
  v_mfma_f32_32x32x16_bf16 v[72:87], v[200:203], v[232:235], v[72:87]
  ds_read_b64_tr_b16 v[216:217], v28 offset:4096
  ds_read_b64_tr_b16 v[218:219], v28 offset:5120
  ds_read_b64_tr_b16 v[220:221], v29 offset:4096
  ds_read_b64_tr_b16 v[222:223], v29 offset:5120
  s_waitcnt lgkmcnt(9)
  v_mfma_f32_32x32x16_bf16 v[88:103], v[204:207], v[232:235], v[88:103]
  ds_read_b64_tr_b16 v[224:225], v30 offset:4096
  ds_read_b64_tr_b16 v[226:227], v30 offset:5120
  ds_read_b64_tr_b16 v[228:229], v31 offset:4096
  ds_read_b64_tr_b16 v[230:231], v31 offset:5120
  s_waitcnt lgkmcnt(11)
  v_mfma_f32_32x32x16_bf16 v[104:119], v[208:211], v[232:235], v[104:119]
  s_add_u32 s43, s43, 1
  s_add_u32 s34, s43, s74
  s_and_b32 s34, s34, 3
  s_and_b32 s36, s43, 252
  s_or_b32 s34, s34, s36
  s_lshl_b32 s34, s34, 19
  s_add_u32 s29, s34, s86
  s_waitcnt lgkmcnt(9)
  v_mfma_f32_32x32x16_bf16 v[120:135], v[212:215], v[232:235], v[120:135]
  s_waitcnt vmcnt(8) lgkmcnt(0)
  s_barrier
  v_mfma_f32_32x32x16_bf16 v[72:87], v[216:219], v[236:239], v[72:87]
  ds_read_b128 v[168:171], v242 offset:0
  ds_read_b64_tr_b16 v[136:137], v28 offset:8192
  ds_read_b64_tr_b16 v[138:139], v28 offset:9216
  s_add_u32 m0, s84, 49152
  s_add_u32 s35, s29, 0
  buffer_load_dwordx4 v13, s[8:11], s35 offen  lds
  v_mfma_f32_32x32x16_bf16 v[88:103], v[220:223], v[236:239], v[88:103]
  ds_read_b64_tr_b16 v[140:141], v29 offset:8192
  ds_read_b64_tr_b16 v[142:143], v29 offset:9216
  ds_read_b64_tr_b16 v[144:145], v30 offset:8192
  s_add_u32 m0, s84, 50176
  s_add_u32 s35, s29, 32768
  buffer_load_dwordx4 v13, s[8:11], s35 offen  lds
  v_mfma_f32_32x32x16_bf16 v[104:119], v[224:227], v[236:239], v[104:119]
  ds_read_b64_tr_b16 v[146:147], v30 offset:9216
  ds_read_b64_tr_b16 v[148:149], v31 offset:8192
  v_mfma_f32_32x32x16_bf16 v[120:135], v[228:231], v[236:239], v[120:135]
  ds_read_b64_tr_b16 v[150:151], v31 offset:9216
  ds_read_b128 v[172:175], v243 offset:0
  s_waitcnt lgkmcnt(7)
  v_mfma_f32_32x32x16_bf16 v[72:87], v[136:139], v[168:171], v[72:87]
  ds_read_b64_tr_b16 v[152:153], v28 offset:12288
  ds_read_b64_tr_b16 v[154:155], v28 offset:13312
  ds_read_b64_tr_b16 v[156:157], v29 offset:12288
  ds_read_b64_tr_b16 v[158:159], v29 offset:13312
  s_waitcnt lgkmcnt(9)
  v_mfma_f32_32x32x16_bf16 v[88:103], v[140:143], v[168:171], v[88:103]
  ds_read_b64_tr_b16 v[160:161], v30 offset:12288
  ds_read_b64_tr_b16 v[162:163], v30 offset:13312
  ds_read_b64_tr_b16 v[164:165], v31 offset:12288
  ds_read_b64_tr_b16 v[166:167], v31 offset:13312
  s_waitcnt lgkmcnt(11)
  v_mfma_f32_32x32x16_bf16 v[104:119], v[144:147], v[168:171], v[104:119]
  s_add_u32 s31, s31, 1
  s_add_u32 s34, s31, s74
  s_and_b32 s34, s34, 3
  s_and_b32 s36, s31, 252
  s_or_b32 s34, s34, s36
  s_lshl_b32 s34, s34, 7
  s_add_u32 s30, s34, s87
  s_waitcnt lgkmcnt(9)
  v_mfma_f32_32x32x16_bf16 v[120:135], v[148:151], v[168:171], v[120:135]
  s_waitcnt vmcnt(4) lgkmcnt(0)
  s_barrier
  v_mfma_f32_32x32x16_bf16 v[72:87], v[152:155], v[172:175], v[72:87]
  ds_read_b128 v[232:235], v240 offset:32768
  ds_read_b64_tr_b16 v[200:201], v28 offset:16384
  ds_read_b64_tr_b16 v[202:203], v28 offset:17408
  s_add_u32 m0, s85, 0
  s_add_u32 s35, s30, 0
  buffer_load_dwordx4 v14, s[12:15], s35 offen  lds
  s_add_u32 m0, s85, 1024
  s_add_u32 s35, s30, 16384
  buffer_load_dwordx4 v15, s[12:15], s35 offen  lds
  v_mfma_f32_32x32x16_bf16 v[88:103], v[156:159], v[172:175], v[88:103]
  ds_read_b64_tr_b16 v[204:205], v29 offset:16384
  ds_read_b64_tr_b16 v[206:207], v29 offset:17408
  ds_read_b64_tr_b16 v[208:209], v30 offset:16384
  s_add_u32 m0, s85, 2048
  s_add_u32 s35, s30, 32768
  buffer_load_dwordx4 v14, s[12:15], s35 offen  lds
  s_add_u32 m0, s85, 3072
  s_add_u32 s35, s30, 49152
  buffer_load_dwordx4 v15, s[12:15], s35 offen  lds
  v_mfma_f32_32x32x16_bf16 v[104:119], v[160:163], v[172:175], v[104:119]
  ds_read_b64_tr_b16 v[210:211], v30 offset:17408
  ds_read_b64_tr_b16 v[212:213], v31 offset:16384
  s_add_u32 m0, s84, 57344
  s_add_u32 s35, s29, 262144
  buffer_load_dwordx4 v13, s[8:11], s35 offen  lds
  v_mfma_f32_32x32x16_bf16 v[120:135], v[164:167], v[172:175], v[120:135]
  ds_read_b64_tr_b16 v[214:215], v31 offset:17408
  ds_read_b128 v[236:239], v241 offset:32768
  s_add_u32 m0, s84, 58368
  s_add_u32 s35, s29, 294912
  buffer_load_dwordx4 v13, s[8:11], s35 offen  lds
  s_waitcnt lgkmcnt(7)
  v_mfma_f32_32x32x16_bf16 v[72:87], v[200:203], v[232:235], v[72:87]
  ds_read_b64_tr_b16 v[216:217], v28 offset:20480
  ds_read_b64_tr_b16 v[218:219], v28 offset:21504
  ds_read_b64_tr_b16 v[220:221], v29 offset:20480
  ds_read_b64_tr_b16 v[222:223], v29 offset:21504
  s_waitcnt lgkmcnt(9)
  v_mfma_f32_32x32x16_bf16 v[88:103], v[204:207], v[232:235], v[88:103]
  ds_read_b64_tr_b16 v[224:225], v30 offset:20480
  ds_read_b64_tr_b16 v[226:227], v30 offset:21504
  ds_read_b64_tr_b16 v[228:229], v31 offset:20480
  ds_read_b64_tr_b16 v[230:231], v31 offset:21504
  s_waitcnt lgkmcnt(11)
  v_mfma_f32_32x32x16_bf16 v[104:119], v[208:211], v[232:235], v[104:119]
  s_add_u32 s43, s43, 1
  s_add_u32 s34, s43, s74
  s_and_b32 s34, s34, 3
  s_and_b32 s36, s43, 252
  s_or_b32 s34, s34, s36
  s_lshl_b32 s34, s34, 19
  s_add_u32 s29, s34, s86
  s_waitcnt lgkmcnt(9)
  v_mfma_f32_32x32x16_bf16 v[120:135], v[212:215], v[232:235], v[120:135]
  s_waitcnt vmcnt(8) lgkmcnt(0)
  s_barrier
  v_mfma_f32_32x32x16_bf16 v[72:87], v[216:219], v[236:239], v[72:87]
  ds_read_b128 v[168:171], v242 offset:32768
  ds_read_b64_tr_b16 v[136:137], v28 offset:24576
  ds_read_b64_tr_b16 v[138:139], v28 offset:25600
  s_add_u32 m0, s84, 65536
  s_add_u32 s35, s29, 0
  buffer_load_dwordx4 v13, s[8:11], s35 offen  lds
  v_mfma_f32_32x32x16_bf16 v[88:103], v[220:223], v[236:239], v[88:103]
  ds_read_b64_tr_b16 v[140:141], v29 offset:24576
  ds_read_b64_tr_b16 v[142:143], v29 offset:25600
  ds_read_b64_tr_b16 v[144:145], v30 offset:24576
  s_add_u32 m0, s84, 66560
  s_add_u32 s35, s29, 32768
  buffer_load_dwordx4 v13, s[8:11], s35 offen  lds
  v_mfma_f32_32x32x16_bf16 v[104:119], v[224:227], v[236:239], v[104:119]
  ds_read_b64_tr_b16 v[146:147], v30 offset:25600
  ds_read_b64_tr_b16 v[148:149], v31 offset:24576
  v_mfma_f32_32x32x16_bf16 v[120:135], v[228:231], v[236:239], v[120:135]
  ds_read_b64_tr_b16 v[150:151], v31 offset:25600
  ds_read_b128 v[172:175], v243 offset:32768
  s_waitcnt lgkmcnt(7)
  v_mfma_f32_32x32x16_bf16 v[72:87], v[136:139], v[168:171], v[72:87]
  ds_read_b64_tr_b16 v[152:153], v28 offset:28672
  ds_read_b64_tr_b16 v[154:155], v28 offset:29696
  ds_read_b64_tr_b16 v[156:157], v29 offset:28672
  ds_read_b64_tr_b16 v[158:159], v29 offset:29696
  s_waitcnt lgkmcnt(9)
  v_mfma_f32_32x32x16_bf16 v[88:103], v[140:143], v[168:171], v[88:103]
  ds_read_b64_tr_b16 v[160:161], v30 offset:28672
  ds_read_b64_tr_b16 v[162:163], v30 offset:29696
  ds_read_b64_tr_b16 v[164:165], v31 offset:28672
  ds_read_b64_tr_b16 v[166:167], v31 offset:29696
  s_waitcnt lgkmcnt(11)
  v_mfma_f32_32x32x16_bf16 v[104:119], v[144:147], v[168:171], v[104:119]
  s_add_u32 s31, s31, 1
  s_add_u32 s34, s31, s74
  s_and_b32 s34, s34, 3
  s_and_b32 s36, s31, 252
  s_or_b32 s34, s34, s36
  s_lshl_b32 s34, s34, 7
  s_add_u32 s30, s34, s87
  s_waitcnt lgkmcnt(9)
  v_mfma_f32_32x32x16_bf16 v[120:135], v[148:151], v[168:171], v[120:135]
  s_waitcnt vmcnt(4) lgkmcnt(0)
  s_barrier
  v_mfma_f32_32x32x16_bf16 v[72:87], v[152:155], v[172:175], v[72:87]
  ds_read_b128 v[232:235], v240 offset:0
  ds_read_b64_tr_b16 v[200:201], v28 offset:0
  ds_read_b64_tr_b16 v[202:203], v28 offset:1024
  s_add_u32 m0, s85, 32768
  s_add_u32 s35, s30, 0
  buffer_load_dwordx4 v14, s[12:15], s35 offen  lds
  s_add_u32 m0, s85, 33792
  s_add_u32 s35, s30, 16384
  buffer_load_dwordx4 v15, s[12:15], s35 offen  lds
  v_mfma_f32_32x32x16_bf16 v[88:103], v[156:159], v[172:175], v[88:103]
  ds_read_b64_tr_b16 v[204:205], v29 offset:0
  ds_read_b64_tr_b16 v[206:207], v29 offset:1024
  ds_read_b64_tr_b16 v[208:209], v30 offset:0
  s_add_u32 m0, s85, 34816
  s_add_u32 s35, s30, 32768
  buffer_load_dwordx4 v14, s[12:15], s35 offen  lds
  s_add_u32 m0, s85, 35840
  s_add_u32 s35, s30, 49152
  buffer_load_dwordx4 v15, s[12:15], s35 offen  lds
  v_mfma_f32_32x32x16_bf16 v[104:119], v[160:163], v[172:175], v[104:119]
  ds_read_b64_tr_b16 v[210:211], v30 offset:1024
  ds_read_b64_tr_b16 v[212:213], v31 offset:0
  s_add_u32 m0, s84, 73728
  s_add_u32 s35, s29, 262144
  buffer_load_dwordx4 v13, s[8:11], s35 offen  lds
  v_mfma_f32_32x32x16_bf16 v[120:135], v[164:167], v[172:175], v[120:135]
  ds_read_b64_tr_b16 v[214:215], v31 offset:1024
  ds_read_b128 v[236:239], v241 offset:0
  s_add_u32 m0, s84, 74752
  s_add_u32 s35, s29, 294912
  buffer_load_dwordx4 v13, s[8:11], s35 offen  lds
  s_waitcnt lgkmcnt(7)
  v_mfma_f32_32x32x16_bf16 v[72:87], v[200:203], v[232:235], v[72:87]
  ds_read_b64_tr_b16 v[216:217], v28 offset:4096
  ds_read_b64_tr_b16 v[218:219], v28 offset:5120
  ds_read_b64_tr_b16 v[220:221], v29 offset:4096
  ds_read_b64_tr_b16 v[222:223], v29 offset:5120
  s_waitcnt lgkmcnt(9)
  v_mfma_f32_32x32x16_bf16 v[88:103], v[204:207], v[232:235], v[88:103]
  ds_read_b64_tr_b16 v[224:225], v30 offset:4096
  ds_read_b64_tr_b16 v[226:227], v30 offset:5120
  ds_read_b64_tr_b16 v[228:229], v31 offset:4096
  ds_read_b64_tr_b16 v[230:231], v31 offset:5120
  s_waitcnt lgkmcnt(11)
  v_mfma_f32_32x32x16_bf16 v[104:119], v[208:211], v[232:235], v[104:119]
  s_waitcnt lgkmcnt(9)
  v_mfma_f32_32x32x16_bf16 v[120:135], v[212:215], v[232:235], v[120:135]
  s_waitcnt vmcnt(8) lgkmcnt(0)
  s_barrier
  v_mfma_f32_32x32x16_bf16 v[72:87], v[216:219], v[236:239], v[72:87]
  ds_read_b128 v[168:171], v242 offset:0
  ds_read_b64_tr_b16 v[136:137], v28 offset:8192
  ds_read_b64_tr_b16 v[138:139], v28 offset:9216
  v_mfma_f32_32x32x16_bf16 v[88:103], v[220:223], v[236:239], v[88:103]
  ds_read_b64_tr_b16 v[140:141], v29 offset:8192
  ds_read_b64_tr_b16 v[142:143], v29 offset:9216
  ds_read_b64_tr_b16 v[144:145], v30 offset:8192
  v_mfma_f32_32x32x16_bf16 v[104:119], v[224:227], v[236:239], v[104:119]
  ds_read_b64_tr_b16 v[146:147], v30 offset:9216
  ds_read_b64_tr_b16 v[148:149], v31 offset:8192
  v_mfma_f32_32x32x16_bf16 v[120:135], v[228:231], v[236:239], v[120:135]
  ds_read_b64_tr_b16 v[150:151], v31 offset:9216
  ds_read_b128 v[172:175], v243 offset:0
  s_waitcnt lgkmcnt(7)
  v_mfma_f32_32x32x16_bf16 v[72:87], v[136:139], v[168:171], v[72:87]
  ds_read_b64_tr_b16 v[152:153], v28 offset:12288
  ds_read_b64_tr_b16 v[154:155], v28 offset:13312
  ds_read_b64_tr_b16 v[156:157], v29 offset:12288
  ds_read_b64_tr_b16 v[158:159], v29 offset:13312
  s_waitcnt lgkmcnt(9)
  v_mfma_f32_32x32x16_bf16 v[88:103], v[140:143], v[168:171], v[88:103]
  ds_read_b64_tr_b16 v[160:161], v30 offset:12288
  ds_read_b64_tr_b16 v[162:163], v30 offset:13312
  ds_read_b64_tr_b16 v[164:165], v31 offset:12288
  ds_read_b64_tr_b16 v[166:167], v31 offset:13312
  s_waitcnt lgkmcnt(11)
  v_mfma_f32_32x32x16_bf16 v[104:119], v[144:147], v[168:171], v[104:119]
  s_add_u32 s34, s33, 0
  s_add_u32 m0, s41, 0
  s_waitcnt lgkmcnt(9)
  v_mfma_f32_32x32x16_bf16 v[120:135], v[148:151], v[168:171], v[120:135]
  s_waitcnt vmcnt(2) lgkmcnt(0)
  s_barrier
  v_mfma_f32_32x32x16_bf16 v[72:87], v[152:155], v[172:175], v[72:87]
  ds_read_b128 v[232:235], v240 offset:32768
  ds_read_b64_tr_b16 v[200:201], v28 offset:16384
  ds_read_b64_tr_b16 v[202:203], v28 offset:17408
  s_and_b32 s34, s34, 0x7fff
  s_add_u32 s34, s34, s72
  buffer_load_dwordx4 v8, s[16:19], s34 offen offset:0 nt lds
  buffer_load_dwordx4 v9, s[16:19], s34 offen offset:1024 nt lds
  v_mfma_f32_32x32x16_bf16 v[88:103], v[156:159], v[172:175], v[88:103]
  ds_read_b64_tr_b16 v[204:205], v29 offset:16384
  ds_read_b64_tr_b16 v[206:207], v29 offset:17408
  ds_read_b64_tr_b16 v[208:209], v30 offset:16384
  buffer_load_dwordx4 v10, s[16:19], s34 offen offset:2048 nt lds
  buffer_load_dwordx4 v11, s[16:19], s34 offen offset:3072 nt lds
  v_mfma_f32_32x32x16_bf16 v[104:119], v[160:163], v[172:175], v[104:119]
  ds_read_b64_tr_b16 v[210:211], v30 offset:17408
  ds_read_b64_tr_b16 v[212:213], v31 offset:16384
  s_add_u32 s34, s33, 4096
  s_add_u32 m0, s41, 16384
  s_and_b32 s34, s34, 0x7fff
  s_add_u32 s34, s34, s72
  buffer_load_dwordx4 v8, s[16:19], s34 offen offset:0 nt lds
  buffer_load_dwordx4 v9, s[16:19], s34 offen offset:1024 nt lds
  v_mfma_f32_32x32x16_bf16 v[120:135], v[164:167], v[172:175], v[120:135]
  ds_read_b64_tr_b16 v[214:215], v31 offset:17408
  ds_read_b128 v[236:239], v241 offset:32768
  buffer_load_dwordx4 v10, s[16:19], s34 offen offset:2048 nt lds
  buffer_load_dwordx4 v11, s[16:19], s34 offen offset:3072 nt lds
  s_waitcnt lgkmcnt(7)
  v_mfma_f32_32x32x16_bf16 v[72:87], v[200:203], v[232:235], v[72:87]
  ds_read_b64_tr_b16 v[216:217], v28 offset:20480
  ds_read_b64_tr_b16 v[218:219], v28 offset:21504
  ds_read_b64_tr_b16 v[220:221], v29 offset:20480
  ds_read_b64_tr_b16 v[222:223], v29 offset:21504
  s_waitcnt lgkmcnt(9)
  v_mfma_f32_32x32x16_bf16 v[88:103], v[204:207], v[232:235], v[88:103]
  ds_read_b64_tr_b16 v[224:225], v30 offset:20480
  ds_read_b64_tr_b16 v[226:227], v30 offset:21504
  ds_read_b64_tr_b16 v[228:229], v31 offset:20480
  ds_read_b64_tr_b16 v[230:231], v31 offset:21504
  s_waitcnt lgkmcnt(11)
  v_mfma_f32_32x32x16_bf16 v[104:119], v[208:211], v[232:235], v[104:119]
  s_waitcnt lgkmcnt(9)
  v_mfma_f32_32x32x16_bf16 v[120:135], v[212:215], v[232:235], v[120:135]
  s_waitcnt vmcnt(8) lgkmcnt(0)
  s_barrier
  v_mfma_f32_32x32x16_bf16 v[72:87], v[216:219], v[236:239], v[72:87]
  ds_read_b128 v[168:171], v242 offset:32768
  ds_read_b64_tr_b16 v[136:137], v28 offset:24576
  ds_read_b64_tr_b16 v[138:139], v28 offset:25600
  v_mfma_f32_32x32x16_bf16 v[88:103], v[220:223], v[236:239], v[88:103]
  ds_read_b64_tr_b16 v[140:141], v29 offset:24576
  ds_read_b64_tr_b16 v[142:143], v29 offset:25600
  ds_read_b64_tr_b16 v[144:145], v30 offset:24576
  v_mfma_f32_32x32x16_bf16 v[104:119], v[224:227], v[236:239], v[104:119]
  ds_read_b64_tr_b16 v[146:147], v30 offset:25600
  ds_read_b64_tr_b16 v[148:149], v31 offset:24576
  v_mfma_f32_32x32x16_bf16 v[120:135], v[228:231], v[236:239], v[120:135]
  ds_read_b64_tr_b16 v[150:151], v31 offset:25600
  ds_read_b128 v[172:175], v243 offset:32768
  s_waitcnt lgkmcnt(7)
  v_mfma_f32_32x32x16_bf16 v[72:87], v[136:139], v[168:171], v[72:87]
  ds_read_b64_tr_b16 v[152:153], v28 offset:28672
  ds_read_b64_tr_b16 v[154:155], v28 offset:29696
  ds_read_b64_tr_b16 v[156:157], v29 offset:28672
  ds_read_b64_tr_b16 v[158:159], v29 offset:29696
  s_waitcnt lgkmcnt(9)
  v_mfma_f32_32x32x16_bf16 v[88:103], v[140:143], v[168:171], v[88:103]
  ds_read_b64_tr_b16 v[160:161], v30 offset:28672
  ds_read_b64_tr_b16 v[162:163], v30 offset:29696
  ds_read_b64_tr_b16 v[164:165], v31 offset:28672
  ds_read_b64_tr_b16 v[166:167], v31 offset:29696
  s_waitcnt lgkmcnt(11)
  v_mfma_f32_32x32x16_bf16 v[104:119], v[144:147], v[168:171], v[104:119]
  s_waitcnt lgkmcnt(9)
  v_mfma_f32_32x32x16_bf16 v[120:135], v[148:151], v[168:171], v[120:135]
  s_waitcnt lgkmcnt(0)
  v_mfma_f32_32x32x16_bf16 v[72:87], v[152:155], v[172:175], v[72:87]
  v_mfma_f32_32x32x16_bf16 v[88:103], v[156:159], v[172:175], v[88:103]
  v_mfma_f32_32x32x16_bf16 v[104:119], v[160:163], v[172:175], v[104:119]
  v_mfma_f32_32x32x16_bf16 v[120:135], v[164:167], v[172:175], v[120:135]
s_nop 8
  v_cvt_pk_bf16_f32 v40, v72, v73
  v_cvt_pk_bf16_f32 v41, v74, v75
  v_cvt_pk_bf16_f32 v42, v76, v77
  v_cvt_pk_bf16_f32 v43, v78, v79
  v_cvt_pk_bf16_f32 v44, v80, v81
  v_cvt_pk_bf16_f32 v45, v82, v83
  v_cvt_pk_bf16_f32 v46, v84, v85
  v_cvt_pk_bf16_f32 v47, v86, v87
  v_cvt_pk_bf16_f32 v48, v88, v89
  v_cvt_pk_bf16_f32 v49, v90, v91
  v_cvt_pk_bf16_f32 v50, v92, v93
  v_cvt_pk_bf16_f32 v51, v94, v95
  v_cvt_pk_bf16_f32 v52, v96, v97
  v_cvt_pk_bf16_f32 v53, v98, v99
  v_cvt_pk_bf16_f32 v54, v100, v101
  v_cvt_pk_bf16_f32 v55, v102, v103
  v_cvt_pk_bf16_f32 v56, v104, v105
  v_cvt_pk_bf16_f32 v57, v106, v107
  v_cvt_pk_bf16_f32 v58, v108, v109
  v_cvt_pk_bf16_f32 v59, v110, v111
  v_cvt_pk_bf16_f32 v60, v112, v113
  v_cvt_pk_bf16_f32 v61, v114, v115
  v_cvt_pk_bf16_f32 v62, v116, v117
  v_cvt_pk_bf16_f32 v63, v118, v119
  v_cvt_pk_bf16_f32 v64, v120, v121
  v_cvt_pk_bf16_f32 v65, v122, v123
  v_cvt_pk_bf16_f32 v66, v124, v125
  v_cvt_pk_bf16_f32 v67, v126, v127
  v_cvt_pk_bf16_f32 v68, v128, v129
  v_cvt_pk_bf16_f32 v69, v130, v131
  v_cvt_pk_bf16_f32 v70, v132, v133
  v_cvt_pk_bf16_f32 v71, v134, v135
  v_mov_b32 v72, 0
  v_mov_b32 v73, 0
  v_mov_b32 v74, 0
  v_mov_b32 v75, 0
  v_mov_b32 v76, 0
  v_mov_b32 v77, 0
  v_mov_b32 v78, 0
  v_mov_b32 v79, 0
  v_mov_b32 v80, 0
  v_mov_b32 v81, 0
  v_mov_b32 v82, 0
  v_mov_b32 v83, 0
  v_mov_b32 v84, 0
  v_mov_b32 v85, 0
  v_mov_b32 v86, 0
  v_mov_b32 v87, 0
  v_mov_b32 v88, 0
  v_mov_b32 v89, 0
  v_mov_b32 v90, 0
  v_mov_b32 v91, 0
  v_mov_b32 v92, 0
  v_mov_b32 v93, 0
  v_mov_b32 v94, 0
  v_mov_b32 v95, 0
  v_mov_b32 v96, 0
  v_mov_b32 v97, 0
  v_mov_b32 v98, 0
  v_mov_b32 v99, 0
  v_mov_b32 v100, 0
  v_mov_b32 v101, 0
  v_mov_b32 v102, 0
  v_mov_b32 v103, 0
  v_mov_b32 v104, 0
  v_mov_b32 v105, 0
  v_mov_b32 v106, 0
  v_mov_b32 v107, 0
  v_mov_b32 v108, 0
  v_mov_b32 v109, 0
  v_mov_b32 v110, 0
  v_mov_b32 v111, 0
  v_mov_b32 v112, 0
  v_mov_b32 v113, 0
  v_mov_b32 v114, 0
  v_mov_b32 v115, 0
  v_mov_b32 v116, 0
  v_mov_b32 v117, 0
  v_mov_b32 v118, 0
  v_mov_b32 v119, 0
  v_mov_b32 v120, 0
  v_mov_b32 v121, 0
  v_mov_b32 v122, 0
  v_mov_b32 v123, 0
  v_mov_b32 v124, 0
  v_mov_b32 v125, 0
  v_mov_b32 v126, 0
  v_mov_b32 v127, 0
  v_mov_b32 v128, 0
  v_mov_b32 v129, 0
  v_mov_b32 v130, 0
  v_mov_b32 v131, 0
  v_mov_b32 v132, 0
  v_mov_b32 v133, 0
  v_mov_b32 v134, 0
  v_mov_b32 v135, 0
  v_mov_b32 v34, 0xff800000
  v_mov_b32 v35, 0
  s_mov_b32 s28, 0
L_a_B:
  s_add_u32 s34, s33, 8192
  s_add_u32 m0, s41, 32768
  s_and_b32 s34, s34, 0x7fff
  s_add_u32 s34, s34, s72
  s_waitcnt vmcnt(7)
  buffer_load_dwordx4 v8, s[16:19], s34 offen offset:0 nt lds
  s_waitcnt vmcnt(7)
  buffer_load_dwordx4 v9, s[16:19], s34 offen offset:1024 nt lds
  s_waitcnt vmcnt(7)
  buffer_load_dwordx4 v10, s[16:19], s34 offen offset:2048 nt lds
  s_waitcnt vmcnt(7)
  buffer_load_dwordx4 v11, s[16:19], s34 offen offset:3072 nt lds
  s_add_u32 s34, s33, 12288
  s_add_u32 m0, s41, 49152
  s_and_b32 s34, s34, 0x7fff
  s_add_u32 s34, s34, s72
  s_waitcnt vmcnt(7)
  buffer_load_dwordx4 v8, s[16:19], s34 offen offset:0 nt lds
  s_waitcnt vmcnt(7)
  buffer_load_dwordx4 v9, s[16:19], s34 offen offset:1024 nt lds
  s_waitcnt vmcnt(7)
  buffer_load_dwordx4 v10, s[16:19], s34 offen offset:2048 nt lds
  s_waitcnt vmcnt(7)
  buffer_load_dwordx4 v11, s[16:19], s34 offen offset:3072 nt lds
  ds_read_b128 v[200:203], v16 offset:0
  ds_read_b128 v[204:207], v17 offset:0
  ds_read_b128 v[208:211], v18 offset:0
  ds_read_b128 v[212:215], v19 offset:0
  ds_read_b128 v[216:219], v20 offset:0
  ds_read_b128 v[220:223], v21 offset:0
  ds_read_b128 v[224:227], v22 offset:0
  ds_read_b128 v[228:231], v23 offset:0
  s_waitcnt lgkmcnt(7)
  v_mfma_f32_32x32x16_bf16 v[136:151], v[200:203], v[40:43], 0
  s_waitcnt lgkmcnt(6)
  v_mfma_f32_32x32x16_bf16 v[136:151], v[204:207], v[44:47], v[136:151]
  s_waitcnt lgkmcnt(5)
  v_mfma_f32_32x32x16_bf16 v[136:151], v[208:211], v[48:51], v[136:151]
  s_waitcnt lgkmcnt(4)
  v_mfma_f32_32x32x16_bf16 v[136:151], v[212:215], v[52:55], v[136:151]
  s_waitcnt lgkmcnt(3)
  v_mfma_f32_32x32x16_bf16 v[136:151], v[216:219], v[56:59], v[136:151]
  s_waitcnt lgkmcnt(2)
  v_mfma_f32_32x32x16_bf16 v[136:151], v[220:223], v[60:63], v[136:151]
  s_waitcnt lgkmcnt(1)
  v_mfma_f32_32x32x16_bf16 v[136:151], v[224:227], v[64:67], v[136:151]
  s_waitcnt lgkmcnt(0)
  v_mfma_f32_32x32x16_bf16 v[136:151], v[228:231], v[68:71], v[136:151]
  s_add_u32 s34, s33, 16384
  s_add_u32 m0, s41, 0
  s_and_b32 s34, s34, 0x7fff
  s_add_u32 s34, s34, s72
  s_waitcnt vmcnt(6)
  buffer_load_dwordx4 v8, s[16:19], s34 offen offset:0 nt lds
  s_waitcnt vmcnt(6)
  buffer_load_dwordx4 v9, s[16:19], s34 offen offset:1024 nt lds
  s_waitcnt vmcnt(6)
  buffer_load_dwordx4 v10, s[16:19], s34 offen offset:2048 nt lds
  s_waitcnt vmcnt(6)
  buffer_load_dwordx4 v11, s[16:19], s34 offen offset:3072 nt lds
  s_add_u32 s34, s33, 20480
  s_add_u32 m0, s41, 16384
  s_and_b32 s34, s34, 0x7fff
  s_add_u32 s34, s34, s72
  s_waitcnt vmcnt(6)
  buffer_load_dwordx4 v8, s[16:19], s34 offen offset:0 nt lds
  s_waitcnt vmcnt(6)
  buffer_load_dwordx4 v9, s[16:19], s34 offen offset:1024 nt lds
  s_waitcnt vmcnt(6)
  buffer_load_dwordx4 v10, s[16:19], s34 offen offset:2048 nt lds
  s_waitcnt vmcnt(6)
  buffer_load_dwordx4 v11, s[16:19], s34 offen offset:3072 nt lds
  ds_read_b128 v[200:203], v16 offset:32768
  ds_read_b128 v[204:207], v17 offset:32768
  ds_read_b128 v[208:211], v18 offset:32768
  ds_read_b128 v[212:215], v19 offset:32768
  ds_read_b128 v[216:219], v20 offset:32768
  ds_read_b128 v[220:223], v21 offset:32768
  ds_read_b128 v[224:227], v22 offset:32768
  ds_read_b128 v[228:231], v23 offset:32768
  s_waitcnt lgkmcnt(7)
  v_mfma_f32_32x32x16_bf16 v[152:167], v[200:203], v[40:43], 0
  s_waitcnt lgkmcnt(6)
  v_mfma_f32_32x32x16_bf16 v[152:167], v[204:207], v[44:47], v[152:167]
  s_waitcnt lgkmcnt(5)
  v_mfma_f32_32x32x16_bf16 v[152:167], v[208:211], v[48:51], v[152:167]
  s_waitcnt lgkmcnt(4)
  v_mfma_f32_32x32x16_bf16 v[152:167], v[212:215], v[52:55], v[152:167]
  s_waitcnt lgkmcnt(3)
  v_mfma_f32_32x32x16_bf16 v[152:167], v[216:219], v[56:59], v[152:167]
  s_waitcnt lgkmcnt(2)
  v_mfma_f32_32x32x16_bf16 v[152:167], v[220:223], v[60:63], v[152:167]
  s_waitcnt lgkmcnt(1)
  v_mfma_f32_32x32x16_bf16 v[152:167], v[224:227], v[64:67], v[152:167]
  s_waitcnt lgkmcnt(0)
  v_mfma_f32_32x32x16_bf16 v[152:167], v[228:231], v[68:71], v[152:167]
  s_add_u32 s34, s33, 24576
  s_add_u32 m0, s41, 32768
  s_and_b32 s34, s34, 0x7fff
  s_add_u32 s34, s34, s72
  s_waitcnt vmcnt(6)
  buffer_load_dwordx4 v8, s[16:19], s34 offen offset:0 nt lds
  s_waitcnt vmcnt(6)
  buffer_load_dwordx4 v9, s[16:19], s34 offen offset:1024 nt lds
  s_waitcnt vmcnt(6)
  buffer_load_dwordx4 v10, s[16:19], s34 offen offset:2048 nt lds
  s_waitcnt vmcnt(6)
  buffer_load_dwordx4 v11, s[16:19], s34 offen offset:3072 nt lds
  s_add_u32 s34, s33, 28672
  s_add_u32 m0, s41, 49152
  s_and_b32 s34, s34, 0x7fff
  s_add_u32 s34, s34, s72
  s_waitcnt vmcnt(6)
  buffer_load_dwordx4 v8, s[16:19], s34 offen offset:0 nt lds
  s_waitcnt vmcnt(6)
  buffer_load_dwordx4 v9, s[16:19], s34 offen offset:1024 nt lds
  s_waitcnt vmcnt(6)
  buffer_load_dwordx4 v10, s[16:19], s34 offen offset:2048 nt lds
  s_waitcnt vmcnt(6)
  buffer_load_dwordx4 v11, s[16:19], s34 offen offset:3072 nt lds
  ds_read_b128 v[200:203], v16 offset:0
  ds_read_b128 v[204:207], v17 offset:0
  ds_read_b128 v[208:211], v18 offset:0
  ds_read_b128 v[212:215], v19 offset:0
  ds_read_b128 v[216:219], v20 offset:0
  ds_read_b128 v[220:223], v21 offset:0
  ds_read_b128 v[224:227], v22 offset:0
  ds_read_b128 v[228:231], v23 offset:0
  s_waitcnt lgkmcnt(7)
  v_mfma_f32_32x32x16_bf16 v[168:183], v[200:203], v[40:43], 0
  s_waitcnt lgkmcnt(6)
  v_mfma_f32_32x32x16_bf16 v[168:183], v[204:207], v[44:47], v[168:183]
  s_waitcnt lgkmcnt(5)
  v_mfma_f32_32x32x16_bf16 v[168:183], v[208:211], v[48:51], v[168:183]
  s_waitcnt lgkmcnt(4)
  v_mfma_f32_32x32x16_bf16 v[168:183], v[212:215], v[52:55], v[168:183]
  s_waitcnt lgkmcnt(3)
  v_mfma_f32_32x32x16_bf16 v[168:183], v[216:219], v[56:59], v[168:183]
  s_waitcnt lgkmcnt(2)
  v_mfma_f32_32x32x16_bf16 v[168:183], v[220:223], v[60:63], v[168:183]
  s_waitcnt lgkmcnt(1)
  v_mfma_f32_32x32x16_bf16 v[168:183], v[224:227], v[64:67], v[168:183]
  s_waitcnt lgkmcnt(0)
  v_mfma_f32_32x32x16_bf16 v[168:183], v[228:231], v[68:71], v[168:183]
  s_add_u32 s34, s33, 0
  s_add_u32 m0, s41, 0
  s_and_b32 s34, s34, 0x7fff
  s_add_u32 s34, s34, s72
  s_waitcnt vmcnt(6)
  buffer_load_dwordx4 v12, s[20:23], s34 offen offset:0 nt lds
  s_waitcnt vmcnt(6)
  buffer_load_dwordx4 v12, s[20:23], s34 offen offset:1024 nt lds
  s_waitcnt vmcnt(6)
  buffer_load_dwordx4 v12, s[20:23], s34 offen offset:2048 nt lds
  s_waitcnt vmcnt(6)
  buffer_load_dwordx4 v12, s[20:23], s34 offen offset:3072 nt lds
  s_add_u32 s34, s33, 4096
  s_add_u32 m0, s41, 16384
  s_and_b32 s34, s34, 0x7fff
  s_add_u32 s34, s34, s72
  s_waitcnt vmcnt(6)
  buffer_load_dwordx4 v12, s[20:23], s34 offen offset:0 nt lds
  s_waitcnt vmcnt(6)
  buffer_load_dwordx4 v12, s[20:23], s34 offen offset:1024 nt lds
  s_waitcnt vmcnt(6)
  buffer_load_dwordx4 v12, s[20:23], s34 offen offset:2048 nt lds
  s_waitcnt vmcnt(6)
  buffer_load_dwordx4 v12, s[20:23], s34 offen offset:3072 nt lds
  ds_read_b128 v[200:203], v16 offset:32768
  ds_read_b128 v[204:207], v17 offset:32768
  ds_read_b128 v[208:211], v18 offset:32768
  ds_read_b128 v[212:215], v19 offset:32768
  ds_read_b128 v[216:219], v20 offset:32768
  ds_read_b128 v[220:223], v21 offset:32768
  ds_read_b128 v[224:227], v22 offset:32768
  ds_read_b128 v[228:231], v23 offset:32768
  s_waitcnt lgkmcnt(7)
  v_mfma_f32_32x32x16_bf16 v[184:199], v[200:203], v[40:43], 0
  s_waitcnt lgkmcnt(6)
  v_mfma_f32_32x32x16_bf16 v[184:199], v[204:207], v[44:47], v[184:199]
  s_waitcnt lgkmcnt(5)
  v_mfma_f32_32x32x16_bf16 v[184:199], v[208:211], v[48:51], v[184:199]
  s_waitcnt lgkmcnt(4)
  v_mfma_f32_32x32x16_bf16 v[184:199], v[212:215], v[52:55], v[184:199]
  s_waitcnt lgkmcnt(3)
  v_mfma_f32_32x32x16_bf16 v[184:199], v[216:219], v[56:59], v[184:199]
  s_waitcnt lgkmcnt(2)
  v_mfma_f32_32x32x16_bf16 v[184:199], v[220:223], v[60:63], v[184:199]
  s_waitcnt lgkmcnt(1)
  v_mfma_f32_32x32x16_bf16 v[184:199], v[224:227], v[64:67], v[184:199]
  s_waitcnt lgkmcnt(0)
  v_mfma_f32_32x32x16_bf16 v[184:199], v[228:231], v[68:71], v[184:199]
  v_max3_f32 v36, v136, v137, v138
  v_max3_f32 v37, v139, v140, v141
  v_max3_f32 v36, v36, v142, v143
  v_max3_f32 v37, v37, v144, v145
  v_max3_f32 v36, v36, v146, v147
  v_max3_f32 v37, v37, v148, v149
  v_max3_f32 v36, v36, v150, v151
  v_max3_f32 v37, v37, v152, v153
  v_max3_f32 v36, v36, v154, v155
  v_max3_f32 v37, v37, v156, v157
  v_max3_f32 v36, v36, v158, v159
  v_max3_f32 v37, v37, v160, v161
  v_max3_f32 v36, v36, v162, v163
  v_max3_f32 v37, v37, v164, v165
  v_max3_f32 v36, v36, v166, v167
  v_max3_f32 v37, v37, v168, v169
  v_max3_f32 v36, v36, v170, v171
  v_max3_f32 v37, v37, v172, v173
  v_max3_f32 v36, v36, v174, v175
  v_max3_f32 v37, v37, v176, v177
  v_max3_f32 v36, v36, v178, v179
  v_max3_f32 v37, v37, v180, v181
  v_max3_f32 v36, v36, v182, v183
  v_max3_f32 v37, v37, v184, v185
  v_max3_f32 v36, v36, v186, v187
  v_max3_f32 v37, v37, v188, v189
  v_max3_f32 v36, v36, v190, v191
  v_max3_f32 v37, v37, v192, v193
  v_max3_f32 v36, v36, v194, v195
  v_max3_f32 v37, v37, v196, v197
  v_max3_f32 v36, v36, v198, v199
  v_max_f32 v36, v36, v37
  v_mov_b32 v37, v36
s_nop 1
  v_permlane32_swap_b32 v36, v37
  v_max3_f32 v36, v36, v37, v34
  v_sub_f32 v38, v34, v36
  v_mul_f32 v38, s40, v38
  v_exp_f32 v38, v38
  v_mul_f32 v39, s40, v36
  v_sub_f32 v39, 0, v39
  v_mov_b32 v34, v36
  v_fma_f32 v136, v136, s40, v39
  v_fma_f32 v137, v137, s40, v39
  v_fma_f32 v138, v138, s40, v39
  v_fma_f32 v139, v139, s40, v39
  v_fma_f32 v140, v140, s40, v39
  v_fma_f32 v141, v141, s40, v39
  v_fma_f32 v142, v142, s40, v39
  v_fma_f32 v143, v143, s40, v39
  v_exp_f32 v136, v136
  v_exp_f32 v137, v137
  v_exp_f32 v138, v138
  v_exp_f32 v139, v139
  v_exp_f32 v140, v140
  v_exp_f32 v141, v141
  v_exp_f32 v142, v142
  v_exp_f32 v143, v143
  v_mov_b32 v1, v136
  v_mov_b32 v2, v137
  v_mov_b32 v3, v138
  v_mov_b32 v5, v139
  v_add_f32 v1, v1, v140
  v_add_f32 v2, v2, v141
  v_add_f32 v3, v3, v142
  v_add_f32 v5, v5, v143
  v_cvt_pk_bf16_f32 v136, v136, v137
  v_cvt_pk_bf16_f32 v137, v138, v139
  v_cvt_pk_bf16_f32 v138, v140, v141
  v_cvt_pk_bf16_f32 v139, v142, v143
  v_fma_f32 v144, v144, s40, v39
  v_fma_f32 v145, v145, s40, v39
  v_fma_f32 v146, v146, s40, v39
  v_fma_f32 v147, v147, s40, v39
  v_fma_f32 v148, v148, s40, v39
  v_fma_f32 v149, v149, s40, v39
  v_fma_f32 v150, v150, s40, v39
  v_fma_f32 v151, v151, s40, v39
  v_exp_f32 v144, v144
  v_exp_f32 v145, v145
  v_exp_f32 v146, v146
  v_exp_f32 v147, v147
  v_exp_f32 v148, v148
  v_exp_f32 v149, v149
  v_exp_f32 v150, v150
  v_exp_f32 v151, v151
  v_add_f32 v1, v1, v144
  v_add_f32 v2, v2, v145
  v_add_f32 v3, v3, v146
  v_add_f32 v5, v5, v147
  v_add_f32 v1, v1, v148
  v_add_f32 v2, v2, v149
  v_add_f32 v3, v3, v150
  v_add_f32 v5, v5, v151
  v_cvt_pk_bf16_f32 v140, v144, v145
  v_cvt_pk_bf16_f32 v141, v146, v147
  v_cvt_pk_bf16_f32 v142, v148, v149
  v_cvt_pk_bf16_f32 v143, v150, v151
  v_fma_f32 v152, v152, s40, v39
  v_fma_f32 v153, v153, s40, v39
  v_fma_f32 v154, v154, s40, v39
  v_fma_f32 v155, v155, s40, v39
  v_fma_f32 v156, v156, s40, v39
  v_fma_f32 v157, v157, s40, v39
  v_fma_f32 v158, v158, s40, v39
  v_fma_f32 v159, v159, s40, v39
  v_exp_f32 v152, v152
  v_exp_f32 v153, v153
  v_exp_f32 v154, v154
  v_exp_f32 v155, v155
  v_exp_f32 v156, v156
  v_exp_f32 v157, v157
  v_exp_f32 v158, v158
  v_exp_f32 v159, v159
  v_add_f32 v1, v1, v152
  v_add_f32 v2, v2, v153
  v_add_f32 v3, v3, v154
  v_add_f32 v5, v5, v155
  v_add_f32 v1, v1, v156
  v_add_f32 v2, v2, v157
  v_add_f32 v3, v3, v158
  v_add_f32 v5, v5, v159
  v_cvt_pk_bf16_f32 v144, v152, v153
  v_cvt_pk_bf16_f32 v145, v154, v155
  v_cvt_pk_bf16_f32 v146, v156, v157
  v_cvt_pk_bf16_f32 v147, v158, v159
  v_fma_f32 v160, v160, s40, v39
  v_fma_f32 v161, v161, s40, v39
  v_fma_f32 v162, v162, s40, v39
  v_fma_f32 v163, v163, s40, v39
  v_fma_f32 v164, v164, s40, v39
  v_fma_f32 v165, v165, s40, v39
  v_fma_f32 v166, v166, s40, v39
  v_fma_f32 v167, v167, s40, v39
  v_exp_f32 v160, v160
  v_exp_f32 v161, v161
  v_exp_f32 v162, v162
  v_exp_f32 v163, v163
  v_exp_f32 v164, v164
  v_exp_f32 v165, v165
  v_exp_f32 v166, v166
  v_exp_f32 v167, v167
  v_add_f32 v1, v1, v160
  v_add_f32 v2, v2, v161
  v_add_f32 v3, v3, v162
  v_add_f32 v5, v5, v163
  v_add_f32 v1, v1, v164
  v_add_f32 v2, v2, v165
  v_add_f32 v3, v3, v166
  v_add_f32 v5, v5, v167
  v_cvt_pk_bf16_f32 v148, v160, v161
  v_cvt_pk_bf16_f32 v149, v162, v163
  v_cvt_pk_bf16_f32 v150, v164, v165
  v_cvt_pk_bf16_f32 v151, v166, v167
  v_fma_f32 v168, v168, s40, v39
  v_fma_f32 v169, v169, s40, v39
  v_fma_f32 v170, v170, s40, v39
  v_fma_f32 v171, v171, s40, v39
  v_fma_f32 v172, v172, s40, v39
  v_fma_f32 v173, v173, s40, v39
  v_fma_f32 v174, v174, s40, v39
  v_fma_f32 v175, v175, s40, v39
  v_exp_f32 v168, v168
  v_exp_f32 v169, v169
  v_exp_f32 v170, v170
  v_exp_f32 v171, v171
  v_exp_f32 v172, v172
  v_exp_f32 v173, v173
  v_exp_f32 v174, v174
  v_exp_f32 v175, v175
  v_add_f32 v1, v1, v168
  v_add_f32 v2, v2, v169
  v_add_f32 v3, v3, v170
  v_add_f32 v5, v5, v171
  v_add_f32 v1, v1, v172
  v_add_f32 v2, v2, v173
  v_add_f32 v3, v3, v174
  v_add_f32 v5, v5, v175
  v_cvt_pk_bf16_f32 v152, v168, v169
  v_cvt_pk_bf16_f32 v153, v170, v171
  v_cvt_pk_bf16_f32 v154, v172, v173
  v_cvt_pk_bf16_f32 v155, v174, v175
  v_fma_f32 v176, v176, s40, v39
  v_fma_f32 v177, v177, s40, v39
  v_fma_f32 v178, v178, s40, v39
  v_fma_f32 v179, v179, s40, v39
  v_fma_f32 v180, v180, s40, v39
  v_fma_f32 v181, v181, s40, v39
  v_fma_f32 v182, v182, s40, v39
  v_fma_f32 v183, v183, s40, v39
  v_exp_f32 v176, v176
  v_exp_f32 v177, v177
  v_exp_f32 v178, v178
  v_exp_f32 v179, v179
  v_exp_f32 v180, v180
  v_exp_f32 v181, v181
  v_exp_f32 v182, v182
  v_exp_f32 v183, v183
  v_add_f32 v1, v1, v176
  v_add_f32 v2, v2, v177
  v_add_f32 v3, v3, v178
  v_add_f32 v5, v5, v179
  v_add_f32 v1, v1, v180
  v_add_f32 v2, v2, v181
  v_add_f32 v3, v3, v182
  v_add_f32 v5, v5, v183
  v_cvt_pk_bf16_f32 v156, v176, v177
  v_cvt_pk_bf16_f32 v157, v178, v179
  v_cvt_pk_bf16_f32 v158, v180, v181
  v_cvt_pk_bf16_f32 v159, v182, v183
  v_fma_f32 v184, v184, s40, v39
  v_fma_f32 v185, v185, s40, v39
  v_fma_f32 v186, v186, s40, v39
  v_fma_f32 v187, v187, s40, v39
  v_fma_f32 v188, v188, s40, v39
  v_fma_f32 v189, v189, s40, v39
  v_fma_f32 v190, v190, s40, v39
  v_fma_f32 v191, v191, s40, v39
  v_exp_f32 v184, v184
  v_exp_f32 v185, v185
  v_exp_f32 v186, v186
  v_exp_f32 v187, v187
  v_exp_f32 v188, v188
  v_exp_f32 v189, v189
  v_exp_f32 v190, v190
  v_exp_f32 v191, v191
  v_add_f32 v1, v1, v184
  v_add_f32 v2, v2, v185
  v_add_f32 v3, v3, v186
  v_add_f32 v5, v5, v187
  v_add_f32 v1, v1, v188
  v_add_f32 v2, v2, v189
  v_add_f32 v3, v3, v190
  v_add_f32 v5, v5, v191
  v_cvt_pk_bf16_f32 v160, v184, v185
  v_cvt_pk_bf16_f32 v161, v186, v187
  v_cvt_pk_bf16_f32 v162, v188, v189
  v_cvt_pk_bf16_f32 v163, v190, v191
  v_fma_f32 v192, v192, s40, v39
  v_fma_f32 v193, v193, s40, v39
  v_fma_f32 v194, v194, s40, v39
  v_fma_f32 v195, v195, s40, v39
  v_fma_f32 v196, v196, s40, v39
  v_fma_f32 v197, v197, s40, v39
  v_fma_f32 v198, v198, s40, v39
  v_fma_f32 v199, v199, s40, v39
  v_exp_f32 v192, v192
  v_exp_f32 v193, v193
  v_exp_f32 v194, v194
  v_exp_f32 v195, v195
  v_exp_f32 v196, v196
  v_exp_f32 v197, v197
  v_exp_f32 v198, v198
  v_exp_f32 v199, v199
  v_add_f32 v1, v1, v192
  v_add_f32 v2, v2, v193
  v_add_f32 v3, v3, v194
  v_add_f32 v5, v5, v195
  v_add_f32 v1, v1, v196
  v_add_f32 v2, v2, v197
  v_add_f32 v3, v3, v198
  v_add_f32 v5, v5, v199
  v_cvt_pk_bf16_f32 v164, v192, v193
  v_cvt_pk_bf16_f32 v165, v194, v195
  v_cvt_pk_bf16_f32 v166, v196, v197
  v_cvt_pk_bf16_f32 v167, v198, v199
  v_add_f32 v1, v1, v2
  v_add_f32 v3, v3, v5
  v_add_f32 v1, v1, v3
  v_fma_f32 v35, v35, v38, v1
  v_mul_f32 v72, v72, v38
  v_mul_f32 v73, v73, v38
  v_mul_f32 v74, v74, v38
  v_mul_f32 v75, v75, v38
  v_mul_f32 v76, v76, v38
  v_mul_f32 v77, v77, v38
  v_mul_f32 v78, v78, v38
  v_mul_f32 v79, v79, v38
  v_mul_f32 v80, v80, v38
  v_mul_f32 v81, v81, v38
  v_mul_f32 v82, v82, v38
  v_mul_f32 v83, v83, v38
  v_mul_f32 v84, v84, v38
  v_mul_f32 v85, v85, v38
  v_mul_f32 v86, v86, v38
  v_mul_f32 v87, v87, v38
  v_mul_f32 v88, v88, v38
  v_mul_f32 v89, v89, v38
  v_mul_f32 v90, v90, v38
  v_mul_f32 v91, v91, v38
  v_mul_f32 v92, v92, v38
  v_mul_f32 v93, v93, v38
  v_mul_f32 v94, v94, v38
  v_mul_f32 v95, v95, v38
  v_mul_f32 v96, v96, v38
  v_mul_f32 v97, v97, v38
  v_mul_f32 v98, v98, v38
  v_mul_f32 v99, v99, v38
  v_mul_f32 v100, v100, v38
  v_mul_f32 v101, v101, v38
  v_mul_f32 v102, v102, v38
  v_mul_f32 v103, v103, v38
  v_mul_f32 v104, v104, v38
  v_mul_f32 v105, v105, v38
  v_mul_f32 v106, v106, v38
  v_mul_f32 v107, v107, v38
  v_mul_f32 v108, v108, v38
  v_mul_f32 v109, v109, v38
  v_mul_f32 v110, v110, v38
  v_mul_f32 v111, v111, v38
  v_mul_f32 v112, v112, v38
  v_mul_f32 v113, v113, v38
  v_mul_f32 v114, v114, v38
  v_mul_f32 v115, v115, v38
  v_mul_f32 v116, v116, v38
  v_mul_f32 v117, v117, v38
  v_mul_f32 v118, v118, v38
  v_mul_f32 v119, v119, v38
  v_mul_f32 v120, v120, v38
  v_mul_f32 v121, v121, v38
  v_mul_f32 v122, v122, v38
  v_mul_f32 v123, v123, v38
  v_mul_f32 v124, v124, v38
  v_mul_f32 v125, v125, v38
  v_mul_f32 v126, v126, v38
  v_mul_f32 v127, v127, v38
  v_mul_f32 v128, v128, v38
  v_mul_f32 v129, v129, v38
  v_mul_f32 v130, v130, v38
  v_mul_f32 v131, v131, v38
  v_mul_f32 v132, v132, v38
  v_mul_f32 v133, v133, v38
  v_mul_f32 v134, v134, v38
  v_mul_f32 v135, v135, v38
  s_add_u32 s34, s33, 8192
  s_add_u32 m0, s41, 32768
  s_and_b32 s34, s34, 0x7fff
  s_add_u32 s34, s34, s72
  s_waitcnt vmcnt(7)
  buffer_load_dwordx4 v12, s[20:23], s34 offen offset:0 nt lds
  s_waitcnt vmcnt(7)
  buffer_load_dwordx4 v12, s[20:23], s34 offen offset:1024 nt lds
  s_waitcnt vmcnt(7)
  buffer_load_dwordx4 v12, s[20:23], s34 offen offset:2048 nt lds
  s_waitcnt vmcnt(7)
  buffer_load_dwordx4 v12, s[20:23], s34 offen offset:3072 nt lds
  s_add_u32 s34, s33, 12288
  s_add_u32 m0, s41, 49152
  s_and_b32 s34, s34, 0x7fff
  s_add_u32 s34, s34, s72
  s_waitcnt vmcnt(7)
  buffer_load_dwordx4 v12, s[20:23], s34 offen offset:0 nt lds
  s_waitcnt vmcnt(7)
  buffer_load_dwordx4 v12, s[20:23], s34 offen offset:1024 nt lds
  s_waitcnt vmcnt(7)
  buffer_load_dwordx4 v12, s[20:23], s34 offen offset:2048 nt lds
  s_waitcnt vmcnt(7)
  buffer_load_dwordx4 v12, s[20:23], s34 offen offset:3072 nt lds
  ds_read_b64_tr_b16 v[200:201], v24 offset:0
  ds_read_b64_tr_b16 v[202:203], v24 offset:2048
  ds_read_b64_tr_b16 v[208:209], v25 offset:0
  ds_read_b64_tr_b16 v[210:211], v25 offset:2048
  ds_read_b64_tr_b16 v[216:217], v26 offset:0
  ds_read_b64_tr_b16 v[218:219], v26 offset:2048
  ds_read_b64_tr_b16 v[224:225], v27 offset:0
  ds_read_b64_tr_b16 v[226:227], v27 offset:2048
  ds_read_b64_tr_b16 v[204:205], v24 offset:16384
  ds_read_b64_tr_b16 v[206:207], v24 offset:18432
  ds_read_b64_tr_b16 v[212:213], v25 offset:16384
  ds_read_b64_tr_b16 v[214:215], v25 offset:18432
  ds_read_b64_tr_b16 v[220:221], v26 offset:16384
  ds_read_b64_tr_b16 v[222:223], v26 offset:18432
  ds_read_b64_tr_b16 v[228:229], v27 offset:16384
  ds_read_b64_tr_b16 v[230:231], v27 offset:18432
  s_waitcnt lgkmcnt(14)
  v_mfma_f32_32x32x16_bf16 v[72:87], v[200:203], v[136:139], v[72:87]
  s_waitcnt lgkmcnt(12)
  v_mfma_f32_32x32x16_bf16 v[88:103], v[208:211], v[136:139], v[88:103]
  s_waitcnt lgkmcnt(10)
  v_mfma_f32_32x32x16_bf16 v[104:119], v[216:219], v[136:139], v[104:119]
  s_waitcnt lgkmcnt(8)
  v_mfma_f32_32x32x16_bf16 v[120:135], v[224:227], v[136:139], v[120:135]
  s_waitcnt lgkmcnt(6)
  v_mfma_f32_32x32x16_bf16 v[72:87], v[204:207], v[140:143], v[72:87]
  s_waitcnt lgkmcnt(4)
  v_mfma_f32_32x32x16_bf16 v[88:103], v[212:215], v[140:143], v[88:103]
  s_waitcnt lgkmcnt(2)
  v_mfma_f32_32x32x16_bf16 v[104:119], v[220:223], v[140:143], v[104:119]
  s_waitcnt lgkmcnt(0)
  v_mfma_f32_32x32x16_bf16 v[120:135], v[228:231], v[140:143], v[120:135]
  s_add_u32 s34, s33, 16384
  s_add_u32 m0, s41, 0
  s_and_b32 s34, s34, 0x7fff
  s_add_u32 s34, s34, s72
  s_waitcnt vmcnt(6)
  buffer_load_dwordx4 v12, s[20:23], s34 offen offset:0 nt lds
  s_waitcnt vmcnt(6)
  buffer_load_dwordx4 v12, s[20:23], s34 offen offset:1024 nt lds
  s_waitcnt vmcnt(6)
  buffer_load_dwordx4 v12, s[20:23], s34 offen offset:2048 nt lds
  s_waitcnt vmcnt(6)
  buffer_load_dwordx4 v12, s[20:23], s34 offen offset:3072 nt lds
  s_add_u32 s34, s33, 20480
  s_add_u32 m0, s41, 16384
  s_and_b32 s34, s34, 0x7fff
  s_add_u32 s34, s34, s72
  s_waitcnt vmcnt(6)
  buffer_load_dwordx4 v12, s[20:23], s34 offen offset:0 nt lds
  s_waitcnt vmcnt(6)
  buffer_load_dwordx4 v12, s[20:23], s34 offen offset:1024 nt lds
  s_waitcnt vmcnt(6)
  buffer_load_dwordx4 v12, s[20:23], s34 offen offset:2048 nt lds
  s_waitcnt vmcnt(6)
  buffer_load_dwordx4 v12, s[20:23], s34 offen offset:3072 nt lds
  ds_read_b64_tr_b16 v[200:201], v24 offset:32768
  ds_read_b64_tr_b16 v[202:203], v24 offset:34816
  ds_read_b64_tr_b16 v[208:209], v25 offset:32768
  ds_read_b64_tr_b16 v[210:211], v25 offset:34816
  ds_read_b64_tr_b16 v[216:217], v26 offset:32768
  ds_read_b64_tr_b16 v[218:219], v26 offset:34816
  ds_read_b64_tr_b16 v[224:225], v27 offset:32768
  ds_read_b64_tr_b16 v[226:227], v27 offset:34816
  ds_read_b64_tr_b16 v[204:205], v24 offset:49152
  ds_read_b64_tr_b16 v[206:207], v24 offset:51200
  ds_read_b64_tr_b16 v[212:213], v25 offset:49152
  ds_read_b64_tr_b16 v[214:215], v25 offset:51200
  ds_read_b64_tr_b16 v[220:221], v26 offset:49152
  ds_read_b64_tr_b16 v[222:223], v26 offset:51200
  ds_read_b64_tr_b16 v[228:229], v27 offset:49152
  ds_read_b64_tr_b16 v[230:231], v27 offset:51200
  s_waitcnt lgkmcnt(14)
  v_mfma_f32_32x32x16_bf16 v[72:87], v[200:203], v[144:147], v[72:87]
  s_waitcnt lgkmcnt(12)
  v_mfma_f32_32x32x16_bf16 v[88:103], v[208:211], v[144:147], v[88:103]
  s_waitcnt lgkmcnt(10)
  v_mfma_f32_32x32x16_bf16 v[104:119], v[216:219], v[144:147], v[104:119]
  s_waitcnt lgkmcnt(8)
  v_mfma_f32_32x32x16_bf16 v[120:135], v[224:227], v[144:147], v[120:135]
  s_waitcnt lgkmcnt(6)
  v_mfma_f32_32x32x16_bf16 v[72:87], v[204:207], v[148:151], v[72:87]
  s_waitcnt lgkmcnt(4)
  v_mfma_f32_32x32x16_bf16 v[88:103], v[212:215], v[148:151], v[88:103]
  s_waitcnt lgkmcnt(2)
  v_mfma_f32_32x32x16_bf16 v[104:119], v[220:223], v[148:151], v[104:119]
  s_waitcnt lgkmcnt(0)
  v_mfma_f32_32x32x16_bf16 v[120:135], v[228:231], v[148:151], v[120:135]
  s_add_u32 s34, s33, 24576
  s_add_u32 m0, s41, 32768
  s_and_b32 s34, s34, 0x7fff
  s_add_u32 s34, s34, s72
  s_waitcnt vmcnt(6)
  buffer_load_dwordx4 v12, s[20:23], s34 offen offset:0 nt lds
  s_waitcnt vmcnt(6)
  buffer_load_dwordx4 v12, s[20:23], s34 offen offset:1024 nt lds
  s_waitcnt vmcnt(6)
  buffer_load_dwordx4 v12, s[20:23], s34 offen offset:2048 nt lds
  s_waitcnt vmcnt(6)
  buffer_load_dwordx4 v12, s[20:23], s34 offen offset:3072 nt lds
  s_add_u32 s34, s33, 28672
  s_add_u32 m0, s41, 49152
  s_and_b32 s34, s34, 0x7fff
  s_add_u32 s34, s34, s72
  s_waitcnt vmcnt(6)
  buffer_load_dwordx4 v12, s[20:23], s34 offen offset:0 nt lds
  s_waitcnt vmcnt(6)
  buffer_load_dwordx4 v12, s[20:23], s34 offen offset:1024 nt lds
  s_waitcnt vmcnt(6)
  buffer_load_dwordx4 v12, s[20:23], s34 offen offset:2048 nt lds
  s_waitcnt vmcnt(6)
  buffer_load_dwordx4 v12, s[20:23], s34 offen offset:3072 nt lds
  ds_read_b64_tr_b16 v[200:201], v24 offset:0
  ds_read_b64_tr_b16 v[202:203], v24 offset:2048
  ds_read_b64_tr_b16 v[208:209], v25 offset:0
  ds_read_b64_tr_b16 v[210:211], v25 offset:2048
  ds_read_b64_tr_b16 v[216:217], v26 offset:0
  ds_read_b64_tr_b16 v[218:219], v26 offset:2048
  ds_read_b64_tr_b16 v[224:225], v27 offset:0
  ds_read_b64_tr_b16 v[226:227], v27 offset:2048
  ds_read_b64_tr_b16 v[204:205], v24 offset:16384
  ds_read_b64_tr_b16 v[206:207], v24 offset:18432
  ds_read_b64_tr_b16 v[212:213], v25 offset:16384
  ds_read_b64_tr_b16 v[214:215], v25 offset:18432
  ds_read_b64_tr_b16 v[220:221], v26 offset:16384
  ds_read_b64_tr_b16 v[222:223], v26 offset:18432
  ds_read_b64_tr_b16 v[228:229], v27 offset:16384
  ds_read_b64_tr_b16 v[230:231], v27 offset:18432
  s_waitcnt lgkmcnt(14)
  v_mfma_f32_32x32x16_bf16 v[72:87], v[200:203], v[152:155], v[72:87]
  s_waitcnt lgkmcnt(12)
  v_mfma_f32_32x32x16_bf16 v[88:103], v[208:211], v[152:155], v[88:103]
  s_waitcnt lgkmcnt(10)
  v_mfma_f32_32x32x16_bf16 v[104:119], v[216:219], v[152:155], v[104:119]
  s_waitcnt lgkmcnt(8)
  v_mfma_f32_32x32x16_bf16 v[120:135], v[224:227], v[152:155], v[120:135]
  s_waitcnt lgkmcnt(6)
  v_mfma_f32_32x32x16_bf16 v[72:87], v[204:207], v[156:159], v[72:87]
  s_waitcnt lgkmcnt(4)
  v_mfma_f32_32x32x16_bf16 v[88:103], v[212:215], v[156:159], v[88:103]
  s_waitcnt lgkmcnt(2)
  v_mfma_f32_32x32x16_bf16 v[104:119], v[220:223], v[156:159], v[104:119]
  s_waitcnt lgkmcnt(0)
  v_mfma_f32_32x32x16_bf16 v[120:135], v[228:231], v[156:159], v[120:135]
  s_cmp_eq_u32 s28, 3
  s_cbranch_scc1 L_w0_B
  s_add_u32 s34, s33, 0
  s_add_u32 m0, s41, 0
  s_and_b32 s34, s34, 0x7fff
  s_add_u32 s34, s34, s73
  s_waitcnt vmcnt(6)
  buffer_load_dwordx4 v8, s[16:19], s34 offen offset:0 nt lds
  s_waitcnt vmcnt(6)
  buffer_load_dwordx4 v9, s[16:19], s34 offen offset:1024 nt lds
  s_waitcnt vmcnt(6)
  buffer_load_dwordx4 v10, s[16:19], s34 offen offset:2048 nt lds
  s_waitcnt vmcnt(6)
  buffer_load_dwordx4 v11, s[16:19], s34 offen offset:3072 nt lds
  s_add_u32 s34, s33, 4096
  s_add_u32 m0, s41, 16384
  s_and_b32 s34, s34, 0x7fff
  s_add_u32 s34, s34, s73
  s_waitcnt vmcnt(6)
  buffer_load_dwordx4 v8, s[16:19], s34 offen offset:0 nt lds
  s_waitcnt vmcnt(6)
  buffer_load_dwordx4 v9, s[16:19], s34 offen offset:1024 nt lds
  s_waitcnt vmcnt(6)
  buffer_load_dwordx4 v10, s[16:19], s34 offen offset:2048 nt lds
  s_waitcnt vmcnt(6)
  buffer_load_dwordx4 v11, s[16:19], s34 offen offset:3072 nt lds
  s_branch L_w1_B
L_w0_B:
  s_waitcnt vmcnt(0)
L_w1_B:
  ds_read_b64_tr_b16 v[200:201], v24 offset:32768
  ds_read_b64_tr_b16 v[202:203], v24 offset:34816
  ds_read_b64_tr_b16 v[208:209], v25 offset:32768
  ds_read_b64_tr_b16 v[210:211], v25 offset:34816
  ds_read_b64_tr_b16 v[216:217], v26 offset:32768
  ds_read_b64_tr_b16 v[218:219], v26 offset:34816
  ds_read_b64_tr_b16 v[224:225], v27 offset:32768
  ds_read_b64_tr_b16 v[226:227], v27 offset:34816
  ds_read_b64_tr_b16 v[204:205], v24 offset:49152
  ds_read_b64_tr_b16 v[206:207], v24 offset:51200
  ds_read_b64_tr_b16 v[212:213], v25 offset:49152
  ds_read_b64_tr_b16 v[214:215], v25 offset:51200
  ds_read_b64_tr_b16 v[220:221], v26 offset:49152
  ds_read_b64_tr_b16 v[222:223], v26 offset:51200
  ds_read_b64_tr_b16 v[228:229], v27 offset:49152
  ds_read_b64_tr_b16 v[230:231], v27 offset:51200
  s_waitcnt lgkmcnt(14)
  v_mfma_f32_32x32x16_bf16 v[72:87], v[200:203], v[160:163], v[72:87]
  s_waitcnt lgkmcnt(12)
  v_mfma_f32_32x32x16_bf16 v[88:103], v[208:211], v[160:163], v[88:103]
  s_waitcnt lgkmcnt(10)
  v_mfma_f32_32x32x16_bf16 v[104:119], v[216:219], v[160:163], v[104:119]
  s_waitcnt lgkmcnt(8)
  v_mfma_f32_32x32x16_bf16 v[120:135], v[224:227], v[160:163], v[120:135]
  s_waitcnt lgkmcnt(6)
  v_mfma_f32_32x32x16_bf16 v[72:87], v[204:207], v[164:167], v[72:87]
  s_waitcnt lgkmcnt(4)
  v_mfma_f32_32x32x16_bf16 v[88:103], v[212:215], v[164:167], v[88:103]
  s_waitcnt lgkmcnt(2)
  v_mfma_f32_32x32x16_bf16 v[104:119], v[220:223], v[164:167], v[104:119]
  s_waitcnt lgkmcnt(0)
  v_mfma_f32_32x32x16_bf16 v[120:135], v[228:231], v[164:167], v[120:135]
  s_mov_b32 s72, s73
  s_add_u32 s73, s73, 32768
  s_and_b32 s73, s73, 0x18000
  s_add_u32 s28, s28, 1
  s_cmp_lt_u32 s28, 4
  s_cbranch_scc1 L_a_B
  s_branch L_fin
L_roleA:
  s_lshr_b32 s74, s74, 1
  s_lshl_b32 s86, s78, 17
  s_lshl_b32 s35, s77, 8
  s_add_u32 s86, s86, s35
  s_lshl_b32 s87, s4, 15
  s_lshl_b32 s84, s77, 13
  s_lshl_b32 s35, s78, 12
  s_add_u32 s84, s84, s35
  s_lshl_b32 s85, s4, 11
  s_lshl_b32 s35, s77, 12
  s_add_u32 s99, s33, s35
  s_add_u32 s100, s41, s35
  s_mov_b32 s43, -1
  s_mov_b32 s31, -1
  s_add_u32 s43, s43, 1
  s_add_u32 s34, s43, s74
  s_and_b32 s34, s34, 3
  s_and_b32 s36, s43, 252
  s_or_b32 s34, s34, s36
  s_lshl_b32 s34, s34, 19
  s_add_u32 s29, s34, s86
  s_add_u32 m0, s84, 0
  s_add_u32 s35, s29, 0
  buffer_load_dwordx4 v13, s[8:11], s35 offen  lds
  s_add_u32 m0, s84, 1024
  s_add_u32 s35, s29, 32768
  buffer_load_dwordx4 v13, s[8:11], s35 offen  lds
  s_add_u32 m0, s84, 2048
  s_add_u32 s35, s29, 65536
  buffer_load_dwordx4 v13, s[8:11], s35 offen  lds
  s_add_u32 m0, s84, 3072
  s_add_u32 s35, s29, 98304
  buffer_load_dwordx4 v13, s[8:11], s35 offen  lds
  s_add_u32 s31, s31, 1
  s_add_u32 s34, s31, s74
  s_and_b32 s34, s34, 3
  s_and_b32 s36, s31, 252
  s_or_b32 s34, s34, s36
  s_lshl_b32 s34, s34, 7
  s_add_u32 s30, s34, s87
  s_add_u32 m0, s85, 65536
  s_add_u32 s35, s30, 0
  buffer_load_dwordx4 v14, s[12:15], s35 offen  lds
  s_add_u32 m0, s85, 66560
  s_add_u32 s35, s30, 16384
  buffer_load_dwordx4 v15, s[12:15], s35 offen  lds
  s_add_u32 m0, s84, 16384
  s_add_u32 s35, s29, 262144
  buffer_load_dwordx4 v13, s[8:11], s35 offen  lds
  s_add_u32 m0, s84, 17408
  s_add_u32 s35, s29, 294912
  buffer_load_dwordx4 v13, s[8:11], s35 offen  lds
  s_add_u32 m0, s84, 18432
  s_add_u32 s35, s29, 327680
  buffer_load_dwordx4 v13, s[8:11], s35 offen  lds
  s_add_u32 m0, s84, 19456
  s_add_u32 s35, s29, 360448
  buffer_load_dwordx4 v13, s[8:11], s35 offen  lds
  s_add_u32 s43, s43, 1
  s_add_u32 s34, s43, s74
  s_and_b32 s34, s34, 3
  s_and_b32 s36, s43, 252
  s_or_b32 s34, s34, s36
  s_lshl_b32 s34, s34, 19
  s_add_u32 s29, s34, s86
  s_add_u32 m0, s84, 32768
  s_add_u32 s35, s29, 0
  buffer_load_dwordx4 v13, s[8:11], s35 offen  lds
  s_add_u32 m0, s84, 33792
  s_add_u32 s35, s29, 32768
  buffer_load_dwordx4 v13, s[8:11], s35 offen  lds
  s_add_u32 m0, s84, 34816
  s_add_u32 s35, s29, 65536
  buffer_load_dwordx4 v13, s[8:11], s35 offen  lds
  s_add_u32 m0, s84, 35840
  s_add_u32 s35, s29, 98304
  buffer_load_dwordx4 v13, s[8:11], s35 offen  lds
  s_add_u32 s31, s31, 1
  s_add_u32 s34, s31, s74
  s_and_b32 s34, s34, 3
  s_and_b32 s36, s31, 252
  s_or_b32 s34, s34, s36
  s_lshl_b32 s34, s34, 7
  s_add_u32 s30, s34, s87
  s_add_u32 m0, s85, 73728
  s_add_u32 s35, s30, 0
  buffer_load_dwordx4 v14, s[12:15], s35 offen  lds
  s_add_u32 m0, s85, 74752
  s_add_u32 s35, s30, 16384
  buffer_load_dwordx4 v15, s[12:15], s35 offen  lds
  s_add_u32 m0, s84, 49152
  s_add_u32 s35, s29, 262144
  buffer_load_dwordx4 v13, s[8:11], s35 offen  lds
  s_add_u32 m0, s84, 50176
  s_add_u32 s35, s29, 294912
  buffer_load_dwordx4 v13, s[8:11], s35 offen  lds
  s_add_u32 m0, s84, 51200
  s_add_u32 s35, s29, 327680
  buffer_load_dwordx4 v13, s[8:11], s35 offen  lds
  s_add_u32 m0, s84, 52224
  s_add_u32 s35, s29, 360448
  buffer_load_dwordx4 v13, s[8:11], s35 offen  lds
  v_mov_b32 v72, 0
  v_mov_b32 v73, 0
  v_mov_b32 v74, 0
  v_mov_b32 v75, 0
  v_mov_b32 v76, 0
  v_mov_b32 v77, 0
  v_mov_b32 v78, 0
  v_mov_b32 v79, 0
  v_mov_b32 v80, 0
  v_mov_b32 v81, 0
  v_mov_b32 v82, 0
  v_mov_b32 v83, 0
  v_mov_b32 v84, 0
  v_mov_b32 v85, 0
  v_mov_b32 v86, 0
  v_mov_b32 v87, 0
  v_mov_b32 v88, 0
  v_mov_b32 v89, 0
  v_mov_b32 v90, 0
  v_mov_b32 v91, 0
  v_mov_b32 v92, 0
  v_mov_b32 v93, 0
  v_mov_b32 v94, 0
  v_mov_b32 v95, 0
  v_mov_b32 v96, 0
  v_mov_b32 v97, 0
  v_mov_b32 v98, 0
  v_mov_b32 v99, 0
  v_mov_b32 v100, 0
  v_mov_b32 v101, 0
  v_mov_b32 v102, 0
  v_mov_b32 v103, 0
  v_mov_b32 v104, 0
  v_mov_b32 v105, 0
  v_mov_b32 v106, 0
  v_mov_b32 v107, 0
  v_mov_b32 v108, 0
  v_mov_b32 v109, 0
  v_mov_b32 v110, 0
  v_mov_b32 v111, 0
  v_mov_b32 v112, 0
  v_mov_b32 v113, 0
  v_mov_b32 v114, 0
  v_mov_b32 v115, 0
  v_mov_b32 v116, 0
  v_mov_b32 v117, 0
  v_mov_b32 v118, 0
  v_mov_b32 v119, 0
  v_mov_b32 v120, 0
  v_mov_b32 v121, 0
  v_mov_b32 v122, 0
  v_mov_b32 v123, 0
  v_mov_b32 v124, 0
  v_mov_b32 v125, 0
  v_mov_b32 v126, 0
  v_mov_b32 v127, 0
  v_mov_b32 v128, 0
  v_mov_b32 v129, 0
  v_mov_b32 v130, 0
  v_mov_b32 v131, 0
  v_mov_b32 v132, 0
  v_mov_b32 v133, 0
  v_mov_b32 v134, 0
  v_mov_b32 v135, 0
  s_waitcnt vmcnt(14)
  s_barrier
  ds_read_b128 v[232:235], v240 offset:0
  ds_read_b64_tr_b16 v[200:201], v28 offset:0
  ds_read_b64_tr_b16 v[202:203], v28 offset:1024
  ds_read_b64_tr_b16 v[204:205], v29 offset:0
  ds_read_b64_tr_b16 v[206:207], v29 offset:1024
  ds_read_b64_tr_b16 v[208:209], v30 offset:0
  ds_read_b64_tr_b16 v[210:211], v30 offset:1024
  ds_read_b64_tr_b16 v[212:213], v31 offset:0
  ds_read_b64_tr_b16 v[214:215], v31 offset:1024
  ds_read_b128 v[236:239], v241 offset:0
  s_mov_b32 s28, 6
L_q_A:
  s_waitcnt lgkmcnt(7)
  v_mfma_f32_32x32x16_bf16 v[72:87], v[200:203], v[232:235], v[72:87]
  ds_read_b64_tr_b16 v[216:217], v28 offset:4096
  ds_read_b64_tr_b16 v[218:219], v28 offset:5120
  ds_read_b64_tr_b16 v[220:221], v29 offset:4096
  ds_read_b64_tr_b16 v[222:223], v29 offset:5120
  s_waitcnt lgkmcnt(9)
  v_mfma_f32_32x32x16_bf16 v[88:103], v[204:207], v[232:235], v[88:103]
  ds_read_b64_tr_b16 v[224:225], v30 offset:4096
  ds_read_b64_tr_b16 v[226:227], v30 offset:5120
  ds_read_b64_tr_b16 v[228:229], v31 offset:4096
  ds_read_b64_tr_b16 v[230:231], v31 offset:5120
  s_waitcnt lgkmcnt(11)
  v_mfma_f32_32x32x16_bf16 v[104:119], v[208:211], v[232:235], v[104:119]
  s_add_u32 s43, s43, 1
  s_add_u32 s34, s43, s74
  s_and_b32 s34, s34, 3
  s_and_b32 s36, s43, 252
  s_or_b32 s34, s34, s36
  s_lshl_b32 s34, s34, 19
  s_add_u32 s29, s34, s86
  s_waitcnt lgkmcnt(9)
  v_mfma_f32_32x32x16_bf16 v[120:135], v[212:215], v[232:235], v[120:135]
  s_waitcnt vmcnt(10) lgkmcnt(0)
  s_barrier
  v_mfma_f32_32x32x16_bf16 v[72:87], v[216:219], v[236:239], v[72:87]
  ds_read_b128 v[168:171], v242 offset:0
  ds_read_b64_tr_b16 v[136:137], v28 offset:16384
  ds_read_b64_tr_b16 v[138:139], v28 offset:17408
  s_add_u32 m0, s84, 0
  s_add_u32 s35, s29, 0
  buffer_load_dwordx4 v13, s[8:11], s35 offen  lds
  v_mfma_f32_32x32x16_bf16 v[88:103], v[220:223], v[236:239], v[88:103]
  ds_read_b64_tr_b16 v[140:141], v29 offset:16384
  ds_read_b64_tr_b16 v[142:143], v29 offset:17408
  ds_read_b64_tr_b16 v[144:145], v30 offset:16384
  s_add_u32 m0, s84, 1024
  s_add_u32 s35, s29, 32768
  buffer_load_dwordx4 v13, s[8:11], s35 offen  lds
  v_mfma_f32_32x32x16_bf16 v[104:119], v[224:227], v[236:239], v[104:119]
  ds_read_b64_tr_b16 v[146:147], v30 offset:17408
  ds_read_b64_tr_b16 v[148:149], v31 offset:16384
  s_add_u32 m0, s84, 2048
  s_add_u32 s35, s29, 65536
  buffer_load_dwordx4 v13, s[8:11], s35 offen  lds
  v_mfma_f32_32x32x16_bf16 v[120:135], v[228:231], v[236:239], v[120:135]
  ds_read_b64_tr_b16 v[150:151], v31 offset:17408
  ds_read_b128 v[172:175], v243 offset:0
  s_add_u32 m0, s84, 3072
  s_add_u32 s35, s29, 98304
  buffer_load_dwordx4 v13, s[8:11], s35 offen  lds
  s_waitcnt lgkmcnt(7)
  v_mfma_f32_32x32x16_bf16 v[72:87], v[136:139], v[168:171], v[72:87]
  ds_read_b64_tr_b16 v[152:153], v28 offset:20480
  ds_read_b64_tr_b16 v[154:155], v28 offset:21504
  ds_read_b64_tr_b16 v[156:157], v29 offset:20480
  ds_read_b64_tr_b16 v[158:159], v29 offset:21504
  s_waitcnt lgkmcnt(9)
  v_mfma_f32_32x32x16_bf16 v[88:103], v[140:143], v[168:171], v[88:103]
  ds_read_b64_tr_b16 v[160:161], v30 offset:20480
  ds_read_b64_tr_b16 v[162:163], v30 offset:21504
  ds_read_b64_tr_b16 v[164:165], v31 offset:20480
  ds_read_b64_tr_b16 v[166:167], v31 offset:21504
  s_waitcnt lgkmcnt(11)
  v_mfma_f32_32x32x16_bf16 v[104:119], v[144:147], v[168:171], v[104:119]
  s_add_u32 s31, s31, 1
  s_add_u32 s34, s31, s74
  s_and_b32 s34, s34, 3
  s_and_b32 s36, s31, 252
  s_or_b32 s34, s34, s36
  s_lshl_b32 s34, s34, 7
  s_add_u32 s30, s34, s87
  s_waitcnt lgkmcnt(9)
  v_mfma_f32_32x32x16_bf16 v[120:135], v[148:151], v[168:171], v[120:135]
  s_waitcnt vmcnt(8) lgkmcnt(0)
  s_barrier
  v_mfma_f32_32x32x16_bf16 v[72:87], v[152:155], v[172:175], v[72:87]
  ds_read_b128 v[232:235], v240 offset:8192
  ds_read_b64_tr_b16 v[200:201], v28 offset:32768
  ds_read_b64_tr_b16 v[202:203], v28 offset:33792
  s_add_u32 m0, s85, 65536
  s_add_u32 s35, s30, 0
  buffer_load_dwordx4 v14, s[12:15], s35 offen  lds
  s_add_u32 m0, s85, 66560
  s_add_u32 s35, s30, 16384
  buffer_load_dwordx4 v15, s[12:15], s35 offen  lds
  v_mfma_f32_32x32x16_bf16 v[88:103], v[156:159], v[172:175], v[88:103]
  ds_read_b64_tr_b16 v[204:205], v29 offset:32768
  ds_read_b64_tr_b16 v[206:207], v29 offset:33792
  ds_read_b64_tr_b16 v[208:209], v30 offset:32768
  s_add_u32 m0, s84, 16384
  s_add_u32 s35, s29, 262144
  buffer_load_dwordx4 v13, s[8:11], s35 offen  lds
  s_add_u32 m0, s84, 17408
  s_add_u32 s35, s29, 294912
  buffer_load_dwordx4 v13, s[8:11], s35 offen  lds
  v_mfma_f32_32x32x16_bf16 v[104:119], v[160:163], v[172:175], v[104:119]
  ds_read_b64_tr_b16 v[210:211], v30 offset:33792
  ds_read_b64_tr_b16 v[212:213], v31 offset:32768
  s_add_u32 m0, s84, 18432
  s_add_u32 s35, s29, 327680
  buffer_load_dwordx4 v13, s[8:11], s35 offen  lds
  v_mfma_f32_32x32x16_bf16 v[120:135], v[164:167], v[172:175], v[120:135]
  ds_read_b64_tr_b16 v[214:215], v31 offset:33792
  ds_read_b128 v[236:239], v241 offset:8192
  s_add_u32 m0, s84, 19456
  s_add_u32 s35, s29, 360448
  buffer_load_dwordx4 v13, s[8:11], s35 offen  lds
  s_waitcnt lgkmcnt(7)
  v_mfma_f32_32x32x16_bf16 v[72:87], v[200:203], v[232:235], v[72:87]
  ds_read_b64_tr_b16 v[216:217], v28 offset:36864
  ds_read_b64_tr_b16 v[218:219], v28 offset:37888
  ds_read_b64_tr_b16 v[220:221], v29 offset:36864
  ds_read_b64_tr_b16 v[222:223], v29 offset:37888
  s_waitcnt lgkmcnt(9)
  v_mfma_f32_32x32x16_bf16 v[88:103], v[204:207], v[232:235], v[88:103]
  ds_read_b64_tr_b16 v[224:225], v30 offset:36864
  ds_read_b64_tr_b16 v[226:227], v30 offset:37888
  ds_read_b64_tr_b16 v[228:229], v31 offset:36864
  ds_read_b64_tr_b16 v[230:231], v31 offset:37888
  s_waitcnt lgkmcnt(11)
  v_mfma_f32_32x32x16_bf16 v[104:119], v[208:211], v[232:235], v[104:119]
  s_add_u32 s43, s43, 1
  s_add_u32 s34, s43, s74
  s_and_b32 s34, s34, 3
  s_and_b32 s36, s43, 252
  s_or_b32 s34, s34, s36
  s_lshl_b32 s34, s34, 19
  s_add_u32 s29, s34, s86
  s_waitcnt lgkmcnt(9)
  v_mfma_f32_32x32x16_bf16 v[120:135], v[212:215], v[232:235], v[120:135]
  s_waitcnt vmcnt(10) lgkmcnt(0)
  s_barrier
  v_mfma_f32_32x32x16_bf16 v[72:87], v[216:219], v[236:239], v[72:87]
  ds_read_b128 v[168:171], v242 offset:8192
  ds_read_b64_tr_b16 v[136:137], v28 offset:49152
  ds_read_b64_tr_b16 v[138:139], v28 offset:50176
  s_add_u32 m0, s84, 32768
  s_add_u32 s35, s29, 0
  buffer_load_dwordx4 v13, s[8:11], s35 offen  lds
  v_mfma_f32_32x32x16_bf16 v[88:103], v[220:223], v[236:239], v[88:103]
  ds_read_b64_tr_b16 v[140:141], v29 offset:49152
  ds_read_b64_tr_b16 v[142:143], v29 offset:50176
  ds_read_b64_tr_b16 v[144:145], v30 offset:49152
  s_add_u32 m0, s84, 33792
  s_add_u32 s35, s29, 32768
  buffer_load_dwordx4 v13, s[8:11], s35 offen  lds
  v_mfma_f32_32x32x16_bf16 v[104:119], v[224:227], v[236:239], v[104:119]
  ds_read_b64_tr_b16 v[146:147], v30 offset:50176
  ds_read_b64_tr_b16 v[148:149], v31 offset:49152
  s_add_u32 m0, s84, 34816
  s_add_u32 s35, s29, 65536
  buffer_load_dwordx4 v13, s[8:11], s35 offen  lds
  v_mfma_f32_32x32x16_bf16 v[120:135], v[228:231], v[236:239], v[120:135]
  ds_read_b64_tr_b16 v[150:151], v31 offset:50176
  ds_read_b128 v[172:175], v243 offset:8192
  s_add_u32 m0, s84, 35840
  s_add_u32 s35, s29, 98304
  buffer_load_dwordx4 v13, s[8:11], s35 offen  lds
  s_waitcnt lgkmcnt(7)
  v_mfma_f32_32x32x16_bf16 v[72:87], v[136:139], v[168:171], v[72:87]
  ds_read_b64_tr_b16 v[152:153], v28 offset:53248
  ds_read_b64_tr_b16 v[154:155], v28 offset:54272
  ds_read_b64_tr_b16 v[156:157], v29 offset:53248
  ds_read_b64_tr_b16 v[158:159], v29 offset:54272
  s_waitcnt lgkmcnt(9)
  v_mfma_f32_32x32x16_bf16 v[88:103], v[140:143], v[168:171], v[88:103]
  ds_read_b64_tr_b16 v[160:161], v30 offset:53248
  ds_read_b64_tr_b16 v[162:163], v30 offset:54272
  ds_read_b64_tr_b16 v[164:165], v31 offset:53248
  ds_read_b64_tr_b16 v[166:167], v31 offset:54272
  s_waitcnt lgkmcnt(11)
  v_mfma_f32_32x32x16_bf16 v[104:119], v[144:147], v[168:171], v[104:119]
  s_add_u32 s31, s31, 1
  s_add_u32 s34, s31, s74
  s_and_b32 s34, s34, 3
  s_and_b32 s36, s31, 252
  s_or_b32 s34, s34, s36
  s_lshl_b32 s34, s34, 7
  s_add_u32 s30, s34, s87
  s_waitcnt lgkmcnt(9)
  v_mfma_f32_32x32x16_bf16 v[120:135], v[148:151], v[168:171], v[120:135]
  s_waitcnt vmcnt(8) lgkmcnt(0)
  s_barrier
  v_mfma_f32_32x32x16_bf16 v[72:87], v[152:155], v[172:175], v[72:87]
  ds_read_b128 v[232:235], v240 offset:0
  ds_read_b64_tr_b16 v[200:201], v28 offset:0
  ds_read_b64_tr_b16 v[202:203], v28 offset:1024
  s_add_u32 m0, s85, 73728
  s_add_u32 s35, s30, 0
  buffer_load_dwordx4 v14, s[12:15], s35 offen  lds
  s_add_u32 m0, s85, 74752
  s_add_u32 s35, s30, 16384
  buffer_load_dwordx4 v15, s[12:15], s35 offen  lds
  v_mfma_f32_32x32x16_bf16 v[88:103], v[156:159], v[172:175], v[88:103]
  ds_read_b64_tr_b16 v[204:205], v29 offset:0
  ds_read_b64_tr_b16 v[206:207], v29 offset:1024
  ds_read_b64_tr_b16 v[208:209], v30 offset:0
  s_add_u32 m0, s84, 49152
  s_add_u32 s35, s29, 262144
  buffer_load_dwordx4 v13, s[8:11], s35 offen  lds
  s_add_u32 m0, s84, 50176
  s_add_u32 s35, s29, 294912
  buffer_load_dwordx4 v13, s[8:11], s35 offen  lds
  v_mfma_f32_32x32x16_bf16 v[104:119], v[160:163], v[172:175], v[104:119]
  ds_read_b64_tr_b16 v[210:211], v30 offset:1024
  ds_read_b64_tr_b16 v[212:213], v31 offset:0
  s_add_u32 m0, s84, 51200
  s_add_u32 s35, s29, 327680
  buffer_load_dwordx4 v13, s[8:11], s35 offen  lds
  v_mfma_f32_32x32x16_bf16 v[120:135], v[164:167], v[172:175], v[120:135]
  ds_read_b64_tr_b16 v[214:215], v31 offset:1024
  ds_read_b128 v[236:239], v241 offset:0
  s_add_u32 m0, s84, 52224
  s_add_u32 s35, s29, 360448
  buffer_load_dwordx4 v13, s[8:11], s35 offen  lds
  s_sub_u32 s28, s28, 1
  s_cmp_lg_u32 s28, 0
  s_cbranch_scc1 L_q_A
  s_waitcnt lgkmcnt(7)
  v_mfma_f32_32x32x16_bf16 v[72:87], v[200:203], v[232:235], v[72:87]
  ds_read_b64_tr_b16 v[216:217], v28 offset:4096
  ds_read_b64_tr_b16 v[218:219], v28 offset:5120
  ds_read_b64_tr_b16 v[220:221], v29 offset:4096
  ds_read_b64_tr_b16 v[222:223], v29 offset:5120
  s_waitcnt lgkmcnt(9)
  v_mfma_f32_32x32x16_bf16 v[88:103], v[204:207], v[232:235], v[88:103]
  ds_read_b64_tr_b16 v[224:225], v30 offset:4096
  ds_read_b64_tr_b16 v[226:227], v30 offset:5120
  ds_read_b64_tr_b16 v[228:229], v31 offset:4096
  ds_read_b64_tr_b16 v[230:231], v31 offset:5120
  s_waitcnt lgkmcnt(11)
  v_mfma_f32_32x32x16_bf16 v[104:119], v[208:211], v[232:235], v[104:119]
  s_add_u32 s43, s43, 1
  s_add_u32 s34, s43, s74
  s_and_b32 s34, s34, 3
  s_and_b32 s36, s43, 252
  s_or_b32 s34, s34, s36
  s_lshl_b32 s34, s34, 19
  s_add_u32 s29, s34, s86
  s_waitcnt lgkmcnt(9)
  v_mfma_f32_32x32x16_bf16 v[120:135], v[212:215], v[232:235], v[120:135]
  s_waitcnt vmcnt(10) lgkmcnt(0)
  s_barrier
  v_mfma_f32_32x32x16_bf16 v[72:87], v[216:219], v[236:239], v[72:87]
  ds_read_b128 v[168:171], v242 offset:0
  ds_read_b64_tr_b16 v[136:137], v28 offset:16384
  ds_read_b64_tr_b16 v[138:139], v28 offset:17408
  s_add_u32 m0, s84, 0
  s_add_u32 s35, s29, 0
  buffer_load_dwordx4 v13, s[8:11], s35 offen  lds
  v_mfma_f32_32x32x16_bf16 v[88:103], v[220:223], v[236:239], v[88:103]
  ds_read_b64_tr_b16 v[140:141], v29 offset:16384
  ds_read_b64_tr_b16 v[142:143], v29 offset:17408
  ds_read_b64_tr_b16 v[144:145], v30 offset:16384
  s_add_u32 m0, s84, 1024
  s_add_u32 s35, s29, 32768
  buffer_load_dwordx4 v13, s[8:11], s35 offen  lds
  v_mfma_f32_32x32x16_bf16 v[104:119], v[224:227], v[236:239], v[104:119]
  ds_read_b64_tr_b16 v[146:147], v30 offset:17408
  ds_read_b64_tr_b16 v[148:149], v31 offset:16384
  s_add_u32 m0, s84, 2048
  s_add_u32 s35, s29, 65536
  buffer_load_dwordx4 v13, s[8:11], s35 offen  lds
  v_mfma_f32_32x32x16_bf16 v[120:135], v[228:231], v[236:239], v[120:135]
  ds_read_b64_tr_b16 v[150:151], v31 offset:17408
  ds_read_b128 v[172:175], v243 offset:0
  s_add_u32 m0, s84, 3072
  s_add_u32 s35, s29, 98304
  buffer_load_dwordx4 v13, s[8:11], s35 offen  lds
  s_waitcnt lgkmcnt(7)
  v_mfma_f32_32x32x16_bf16 v[72:87], v[136:139], v[168:171], v[72:87]
  ds_read_b64_tr_b16 v[152:153], v28 offset:20480
  ds_read_b64_tr_b16 v[154:155], v28 offset:21504
  ds_read_b64_tr_b16 v[156:157], v29 offset:20480
  ds_read_b64_tr_b16 v[158:159], v29 offset:21504
  s_waitcnt lgkmcnt(9)
  v_mfma_f32_32x32x16_bf16 v[88:103], v[140:143], v[168:171], v[88:103]
  ds_read_b64_tr_b16 v[160:161], v30 offset:20480
  ds_read_b64_tr_b16 v[162:163], v30 offset:21504
  ds_read_b64_tr_b16 v[164:165], v31 offset:20480
  ds_read_b64_tr_b16 v[166:167], v31 offset:21504
  s_waitcnt lgkmcnt(11)
  v_mfma_f32_32x32x16_bf16 v[104:119], v[144:147], v[168:171], v[104:119]
  s_add_u32 s31, s31, 1
  s_add_u32 s34, s31, s74
  s_and_b32 s34, s34, 3
  s_and_b32 s36, s31, 252
  s_or_b32 s34, s34, s36
  s_lshl_b32 s34, s34, 7
  s_add_u32 s30, s34, s87
  s_waitcnt lgkmcnt(9)
  v_mfma_f32_32x32x16_bf16 v[120:135], v[148:151], v[168:171], v[120:135]
  s_waitcnt vmcnt(8) lgkmcnt(0)
  s_barrier
  v_mfma_f32_32x32x16_bf16 v[72:87], v[152:155], v[172:175], v[72:87]
  ds_read_b128 v[232:235], v240 offset:8192
  ds_read_b64_tr_b16 v[200:201], v28 offset:32768
  ds_read_b64_tr_b16 v[202:203], v28 offset:33792
  s_add_u32 m0, s85, 65536
  s_add_u32 s35, s30, 0
  buffer_load_dwordx4 v14, s[12:15], s35 offen  lds
  s_add_u32 m0, s85, 66560
  s_add_u32 s35, s30, 16384
  buffer_load_dwordx4 v15, s[12:15], s35 offen  lds
  v_mfma_f32_32x32x16_bf16 v[88:103], v[156:159], v[172:175], v[88:103]
  ds_read_b64_tr_b16 v[204:205], v29 offset:32768
  ds_read_b64_tr_b16 v[206:207], v29 offset:33792
  ds_read_b64_tr_b16 v[208:209], v30 offset:32768
  s_add_u32 m0, s84, 16384
  s_add_u32 s35, s29, 262144
  buffer_load_dwordx4 v13, s[8:11], s35 offen  lds
  s_add_u32 m0, s84, 17408
  s_add_u32 s35, s29, 294912
  buffer_load_dwordx4 v13, s[8:11], s35 offen  lds
  v_mfma_f32_32x32x16_bf16 v[104:119], v[160:163], v[172:175], v[104:119]
  ds_read_b64_tr_b16 v[210:211], v30 offset:33792
  ds_read_b64_tr_b16 v[212:213], v31 offset:32768
  s_add_u32 m0, s84, 18432
  s_add_u32 s35, s29, 327680
  buffer_load_dwordx4 v13, s[8:11], s35 offen  lds
  v_mfma_f32_32x32x16_bf16 v[120:135], v[164:167], v[172:175], v[120:135]
  ds_read_b64_tr_b16 v[214:215], v31 offset:33792
  ds_read_b128 v[236:239], v241 offset:8192
  s_add_u32 m0, s84, 19456
  s_add_u32 s35, s29, 360448
  buffer_load_dwordx4 v13, s[8:11], s35 offen  lds
  s_waitcnt lgkmcnt(7)
  v_mfma_f32_32x32x16_bf16 v[72:87], v[200:203], v[232:235], v[72:87]
  ds_read_b64_tr_b16 v[216:217], v28 offset:36864
  ds_read_b64_tr_b16 v[218:219], v28 offset:37888
  ds_read_b64_tr_b16 v[220:221], v29 offset:36864
  ds_read_b64_tr_b16 v[222:223], v29 offset:37888
  s_waitcnt lgkmcnt(9)
  v_mfma_f32_32x32x16_bf16 v[88:103], v[204:207], v[232:235], v[88:103]
  ds_read_b64_tr_b16 v[224:225], v30 offset:36864
  ds_read_b64_tr_b16 v[226:227], v30 offset:37888
  ds_read_b64_tr_b16 v[228:229], v31 offset:36864
  ds_read_b64_tr_b16 v[230:231], v31 offset:37888
  s_waitcnt lgkmcnt(11)
  v_mfma_f32_32x32x16_bf16 v[104:119], v[208:211], v[232:235], v[104:119]
  s_add_u32 s43, s43, 1
  s_add_u32 s34, s43, s74
  s_and_b32 s34, s34, 3
  s_and_b32 s36, s43, 252
  s_or_b32 s34, s34, s36
  s_lshl_b32 s34, s34, 19
  s_add_u32 s29, s34, s86
  s_waitcnt lgkmcnt(9)
  v_mfma_f32_32x32x16_bf16 v[120:135], v[212:215], v[232:235], v[120:135]
  s_waitcnt vmcnt(10) lgkmcnt(0)
  s_barrier
  v_mfma_f32_32x32x16_bf16 v[72:87], v[216:219], v[236:239], v[72:87]
  ds_read_b128 v[168:171], v242 offset:8192
  ds_read_b64_tr_b16 v[136:137], v28 offset:49152
  ds_read_b64_tr_b16 v[138:139], v28 offset:50176
  s_add_u32 m0, s84, 32768
  s_add_u32 s35, s29, 0
  buffer_load_dwordx4 v13, s[8:11], s35 offen  lds
  v_mfma_f32_32x32x16_bf16 v[88:103], v[220:223], v[236:239], v[88:103]
  ds_read_b64_tr_b16 v[140:141], v29 offset:49152
  ds_read_b64_tr_b16 v[142:143], v29 offset:50176
  ds_read_b64_tr_b16 v[144:145], v30 offset:49152
  s_add_u32 m0, s84, 33792
  s_add_u32 s35, s29, 32768
  buffer_load_dwordx4 v13, s[8:11], s35 offen  lds
  v_mfma_f32_32x32x16_bf16 v[104:119], v[224:227], v[236:239], v[104:119]
  ds_read_b64_tr_b16 v[146:147], v30 offset:50176
  ds_read_b64_tr_b16 v[148:149], v31 offset:49152
  s_add_u32 m0, s84, 34816
  s_add_u32 s35, s29, 65536
  buffer_load_dwordx4 v13, s[8:11], s35 offen  lds
  v_mfma_f32_32x32x16_bf16 v[120:135], v[228:231], v[236:239], v[120:135]
  ds_read_b64_tr_b16 v[150:151], v31 offset:50176
  ds_read_b128 v[172:175], v243 offset:8192
  s_add_u32 m0, s84, 35840
  s_add_u32 s35, s29, 98304
  buffer_load_dwordx4 v13, s[8:11], s35 offen  lds
  s_waitcnt lgkmcnt(7)
  v_mfma_f32_32x32x16_bf16 v[72:87], v[136:139], v[168:171], v[72:87]
  ds_read_b64_tr_b16 v[152:153], v28 offset:53248
  ds_read_b64_tr_b16 v[154:155], v28 offset:54272
  ds_read_b64_tr_b16 v[156:157], v29 offset:53248
  ds_read_b64_tr_b16 v[158:159], v29 offset:54272
  s_waitcnt lgkmcnt(9)
  v_mfma_f32_32x32x16_bf16 v[88:103], v[140:143], v[168:171], v[88:103]
  ds_read_b64_tr_b16 v[160:161], v30 offset:53248
  ds_read_b64_tr_b16 v[162:163], v30 offset:54272
  ds_read_b64_tr_b16 v[164:165], v31 offset:53248
  ds_read_b64_tr_b16 v[166:167], v31 offset:54272
  s_waitcnt lgkmcnt(11)
  v_mfma_f32_32x32x16_bf16 v[104:119], v[144:147], v[168:171], v[104:119]
  s_add_u32 s31, s31, 1
  s_add_u32 s34, s31, s74
  s_and_b32 s34, s34, 3
  s_and_b32 s36, s31, 252
  s_or_b32 s34, s34, s36
  s_lshl_b32 s34, s34, 7
  s_add_u32 s30, s34, s87
  s_waitcnt lgkmcnt(9)
  v_mfma_f32_32x32x16_bf16 v[120:135], v[148:151], v[168:171], v[120:135]
  s_waitcnt vmcnt(8) lgkmcnt(0)
  s_barrier
  v_mfma_f32_32x32x16_bf16 v[72:87], v[152:155], v[172:175], v[72:87]
  ds_read_b128 v[232:235], v240 offset:0
  ds_read_b64_tr_b16 v[200:201], v28 offset:0
  ds_read_b64_tr_b16 v[202:203], v28 offset:1024
  s_add_u32 m0, s85, 73728
  s_add_u32 s35, s30, 0
  buffer_load_dwordx4 v14, s[12:15], s35 offen  lds
  s_add_u32 m0, s85, 74752
  s_add_u32 s35, s30, 16384
  buffer_load_dwordx4 v15, s[12:15], s35 offen  lds
  v_mfma_f32_32x32x16_bf16 v[88:103], v[156:159], v[172:175], v[88:103]
  ds_read_b64_tr_b16 v[204:205], v29 offset:0
  ds_read_b64_tr_b16 v[206:207], v29 offset:1024
  ds_read_b64_tr_b16 v[208:209], v30 offset:0
  s_add_u32 m0, s84, 49152
  s_add_u32 s35, s29, 262144
  buffer_load_dwordx4 v13, s[8:11], s35 offen  lds
  s_add_u32 m0, s84, 50176
  s_add_u32 s35, s29, 294912
  buffer_load_dwordx4 v13, s[8:11], s35 offen  lds
  v_mfma_f32_32x32x16_bf16 v[104:119], v[160:163], v[172:175], v[104:119]
  ds_read_b64_tr_b16 v[210:211], v30 offset:1024
  ds_read_b64_tr_b16 v[212:213], v31 offset:0
  s_add_u32 m0, s84, 51200
  s_add_u32 s35, s29, 327680
  buffer_load_dwordx4 v13, s[8:11], s35 offen  lds
  v_mfma_f32_32x32x16_bf16 v[120:135], v[164:167], v[172:175], v[120:135]
  ds_read_b64_tr_b16 v[214:215], v31 offset:1024
  ds_read_b128 v[236:239], v241 offset:0
  s_add_u32 m0, s84, 52224
  s_add_u32 s35, s29, 360448
  buffer_load_dwordx4 v13, s[8:11], s35 offen  lds
  s_waitcnt lgkmcnt(7)
  v_mfma_f32_32x32x16_bf16 v[72:87], v[200:203], v[232:235], v[72:87]
  ds_read_b64_tr_b16 v[216:217], v28 offset:4096
  ds_read_b64_tr_b16 v[218:219], v28 offset:5120
  ds_read_b64_tr_b16 v[220:221], v29 offset:4096
  ds_read_b64_tr_b16 v[222:223], v29 offset:5120
  s_waitcnt lgkmcnt(9)
  v_mfma_f32_32x32x16_bf16 v[88:103], v[204:207], v[232:235], v[88:103]
  ds_read_b64_tr_b16 v[224:225], v30 offset:4096
  ds_read_b64_tr_b16 v[226:227], v30 offset:5120
  ds_read_b64_tr_b16 v[228:229], v31 offset:4096
  ds_read_b64_tr_b16 v[230:231], v31 offset:5120
  s_waitcnt lgkmcnt(11)
  v_mfma_f32_32x32x16_bf16 v[104:119], v[208:211], v[232:235], v[104:119]
  s_add_u32 s34, s99, 0
  s_add_u32 m0, s100, 0
  s_waitcnt lgkmcnt(9)
  v_mfma_f32_32x32x16_bf16 v[120:135], v[212:215], v[232:235], v[120:135]
  s_waitcnt vmcnt(10) lgkmcnt(0)
  s_barrier
  v_mfma_f32_32x32x16_bf16 v[72:87], v[216:219], v[236:239], v[72:87]
  ds_read_b128 v[168:171], v242 offset:0
  ds_read_b64_tr_b16 v[136:137], v28 offset:16384
  ds_read_b64_tr_b16 v[138:139], v28 offset:17408
  s_and_b32 s34, s34, 0x7fff
  s_add_u32 s34, s34, s72
  buffer_load_dwordx4 v8, s[16:19], s34 offen offset:0  lds
  v_mfma_f32_32x32x16_bf16 v[88:103], v[220:223], v[236:239], v[88:103]
  ds_read_b64_tr_b16 v[140:141], v29 offset:16384
  ds_read_b64_tr_b16 v[142:143], v29 offset:17408
  ds_read_b64_tr_b16 v[144:145], v30 offset:16384
  buffer_load_dwordx4 v9, s[16:19], s34 offen offset:1024  lds
  v_mfma_f32_32x32x16_bf16 v[104:119], v[224:227], v[236:239], v[104:119]
  ds_read_b64_tr_b16 v[146:147], v30 offset:17408
  ds_read_b64_tr_b16 v[148:149], v31 offset:16384
  buffer_load_dwordx4 v10, s[16:19], s34 offen offset:2048  lds
  v_mfma_f32_32x32x16_bf16 v[120:135], v[228:231], v[236:239], v[120:135]
  ds_read_b64_tr_b16 v[150:151], v31 offset:17408
  ds_read_b128 v[172:175], v243 offset:0
  buffer_load_dwordx4 v11, s[16:19], s34 offen offset:3072  lds
  s_waitcnt lgkmcnt(7)
  v_mfma_f32_32x32x16_bf16 v[72:87], v[136:139], v[168:171], v[72:87]
  ds_read_b64_tr_b16 v[152:153], v28 offset:20480
  ds_read_b64_tr_b16 v[154:155], v28 offset:21504
  ds_read_b64_tr_b16 v[156:157], v29 offset:20480
  ds_read_b64_tr_b16 v[158:159], v29 offset:21504
  s_waitcnt lgkmcnt(9)
  v_mfma_f32_32x32x16_bf16 v[88:103], v[140:143], v[168:171], v[88:103]
  ds_read_b64_tr_b16 v[160:161], v30 offset:20480
  ds_read_b64_tr_b16 v[162:163], v30 offset:21504
  ds_read_b64_tr_b16 v[164:165], v31 offset:20480
  ds_read_b64_tr_b16 v[166:167], v31 offset:21504
  s_waitcnt lgkmcnt(11)
  v_mfma_f32_32x32x16_bf16 v[104:119], v[144:147], v[168:171], v[104:119]
  s_add_u32 s34, s99, 8192
  s_add_u32 m0, s100, 16384
  s_waitcnt lgkmcnt(9)
  v_mfma_f32_32x32x16_bf16 v[120:135], v[148:151], v[168:171], v[120:135]
  s_waitcnt vmcnt(8) lgkmcnt(0)
  s_barrier
  v_mfma_f32_32x32x16_bf16 v[72:87], v[152:155], v[172:175], v[72:87]
  ds_read_b128 v[232:235], v240 offset:8192
  ds_read_b64_tr_b16 v[200:201], v28 offset:32768
  ds_read_b64_tr_b16 v[202:203], v28 offset:33792
  s_and_b32 s34, s34, 0x7fff
  s_add_u32 s34, s34, s72
  buffer_load_dwordx4 v8, s[16:19], s34 offen offset:0  lds
  v_mfma_f32_32x32x16_bf16 v[88:103], v[156:159], v[172:175], v[88:103]
  ds_read_b64_tr_b16 v[204:205], v29 offset:32768
  ds_read_b64_tr_b16 v[206:207], v29 offset:33792
  ds_read_b64_tr_b16 v[208:209], v30 offset:32768
  buffer_load_dwordx4 v9, s[16:19], s34 offen offset:1024  lds
  v_mfma_f32_32x32x16_bf16 v[104:119], v[160:163], v[172:175], v[104:119]
  ds_read_b64_tr_b16 v[210:211], v30 offset:33792
  ds_read_b64_tr_b16 v[212:213], v31 offset:32768
  buffer_load_dwordx4 v10, s[16:19], s34 offen offset:2048  lds
  v_mfma_f32_32x32x16_bf16 v[120:135], v[164:167], v[172:175], v[120:135]
  ds_read_b64_tr_b16 v[214:215], v31 offset:33792
  ds_read_b128 v[236:239], v241 offset:8192
  buffer_load_dwordx4 v11, s[16:19], s34 offen offset:3072  lds
  s_waitcnt lgkmcnt(7)
  v_mfma_f32_32x32x16_bf16 v[72:87], v[200:203], v[232:235], v[72:87]
  ds_read_b64_tr_b16 v[216:217], v28 offset:36864
  ds_read_b64_tr_b16 v[218:219], v28 offset:37888
  ds_read_b64_tr_b16 v[220:221], v29 offset:36864
  ds_read_b64_tr_b16 v[222:223], v29 offset:37888
  s_waitcnt lgkmcnt(9)
  v_mfma_f32_32x32x16_bf16 v[88:103], v[204:207], v[232:235], v[88:103]
  ds_read_b64_tr_b16 v[224:225], v30 offset:36864
  ds_read_b64_tr_b16 v[226:227], v30 offset:37888
  ds_read_b64_tr_b16 v[228:229], v31 offset:36864
  ds_read_b64_tr_b16 v[230:231], v31 offset:37888
  s_waitcnt lgkmcnt(11)
  v_mfma_f32_32x32x16_bf16 v[104:119], v[208:211], v[232:235], v[104:119]
  s_waitcnt lgkmcnt(9)
  v_mfma_f32_32x32x16_bf16 v[120:135], v[212:215], v[232:235], v[120:135]
  s_waitcnt vmcnt(8) lgkmcnt(0)
  s_barrier
  v_mfma_f32_32x32x16_bf16 v[72:87], v[216:219], v[236:239], v[72:87]
  ds_read_b128 v[168:171], v242 offset:8192
  ds_read_b64_tr_b16 v[136:137], v28 offset:49152
  ds_read_b64_tr_b16 v[138:139], v28 offset:50176
  v_mfma_f32_32x32x16_bf16 v[88:103], v[220:223], v[236:239], v[88:103]
  ds_read_b64_tr_b16 v[140:141], v29 offset:49152
  ds_read_b64_tr_b16 v[142:143], v29 offset:50176
  ds_read_b64_tr_b16 v[144:145], v30 offset:49152
  v_mfma_f32_32x32x16_bf16 v[104:119], v[224:227], v[236:239], v[104:119]
  ds_read_b64_tr_b16 v[146:147], v30 offset:50176
  ds_read_b64_tr_b16 v[148:149], v31 offset:49152
  v_mfma_f32_32x32x16_bf16 v[120:135], v[228:231], v[236:239], v[120:135]
  ds_read_b64_tr_b16 v[150:151], v31 offset:50176
  ds_read_b128 v[172:175], v243 offset:8192
  s_waitcnt lgkmcnt(7)
  v_mfma_f32_32x32x16_bf16 v[72:87], v[136:139], v[168:171], v[72:87]
  ds_read_b64_tr_b16 v[152:153], v28 offset:53248
  ds_read_b64_tr_b16 v[154:155], v28 offset:54272
  ds_read_b64_tr_b16 v[156:157], v29 offset:53248
  ds_read_b64_tr_b16 v[158:159], v29 offset:54272
  s_waitcnt lgkmcnt(9)
  v_mfma_f32_32x32x16_bf16 v[88:103], v[140:143], v[168:171], v[88:103]
  ds_read_b64_tr_b16 v[160:161], v30 offset:53248
  ds_read_b64_tr_b16 v[162:163], v30 offset:54272
  ds_read_b64_tr_b16 v[164:165], v31 offset:53248
  ds_read_b64_tr_b16 v[166:167], v31 offset:54272
  s_waitcnt lgkmcnt(11)
  v_mfma_f32_32x32x16_bf16 v[104:119], v[144:147], v[168:171], v[104:119]
  s_waitcnt lgkmcnt(9)
  v_mfma_f32_32x32x16_bf16 v[120:135], v[148:151], v[168:171], v[120:135]
  s_waitcnt lgkmcnt(0)
  v_mfma_f32_32x32x16_bf16 v[72:87], v[152:155], v[172:175], v[72:87]
  v_mfma_f32_32x32x16_bf16 v[88:103], v[156:159], v[172:175], v[88:103]
  v_mfma_f32_32x32x16_bf16 v[104:119], v[160:163], v[172:175], v[104:119]
  v_mfma_f32_32x32x16_bf16 v[120:135], v[164:167], v[172:175], v[120:135]
s_nop 8
  v_cvt_pk_bf16_f32 v40, v72, v73
  v_cvt_pk_bf16_f32 v41, v74, v75
  v_cvt_pk_bf16_f32 v42, v76, v77
  v_cvt_pk_bf16_f32 v43, v78, v79
  v_cvt_pk_bf16_f32 v44, v80, v81
  v_cvt_pk_bf16_f32 v45, v82, v83
  v_cvt_pk_bf16_f32 v46, v84, v85
  v_cvt_pk_bf16_f32 v47, v86, v87
  v_cvt_pk_bf16_f32 v48, v88, v89
  v_cvt_pk_bf16_f32 v49, v90, v91
  v_cvt_pk_bf16_f32 v50, v92, v93
  v_cvt_pk_bf16_f32 v51, v94, v95
  v_cvt_pk_bf16_f32 v52, v96, v97
  v_cvt_pk_bf16_f32 v53, v98, v99
  v_cvt_pk_bf16_f32 v54, v100, v101
  v_cvt_pk_bf16_f32 v55, v102, v103
  v_cvt_pk_bf16_f32 v56, v104, v105
  v_cvt_pk_bf16_f32 v57, v106, v107
  v_cvt_pk_bf16_f32 v58, v108, v109
  v_cvt_pk_bf16_f32 v59, v110, v111
  v_cvt_pk_bf16_f32 v60, v112, v113
  v_cvt_pk_bf16_f32 v61, v114, v115
  v_cvt_pk_bf16_f32 v62, v116, v117
  v_cvt_pk_bf16_f32 v63, v118, v119
  v_cvt_pk_bf16_f32 v64, v120, v121
  v_cvt_pk_bf16_f32 v65, v122, v123
  v_cvt_pk_bf16_f32 v66, v124, v125
  v_cvt_pk_bf16_f32 v67, v126, v127
  v_cvt_pk_bf16_f32 v68, v128, v129
  v_cvt_pk_bf16_f32 v69, v130, v131
  v_cvt_pk_bf16_f32 v70, v132, v133
  v_cvt_pk_bf16_f32 v71, v134, v135
  v_mov_b32 v72, 0
  v_mov_b32 v73, 0
  v_mov_b32 v74, 0
  v_mov_b32 v75, 0
  v_mov_b32 v76, 0
  v_mov_b32 v77, 0
  v_mov_b32 v78, 0
  v_mov_b32 v79, 0
  v_mov_b32 v80, 0
  v_mov_b32 v81, 0
  v_mov_b32 v82, 0
  v_mov_b32 v83, 0
  v_mov_b32 v84, 0
  v_mov_b32 v85, 0
  v_mov_b32 v86, 0
  v_mov_b32 v87, 0
  v_mov_b32 v88, 0
  v_mov_b32 v89, 0
  v_mov_b32 v90, 0
  v_mov_b32 v91, 0
  v_mov_b32 v92, 0
  v_mov_b32 v93, 0
  v_mov_b32 v94, 0
  v_mov_b32 v95, 0
  v_mov_b32 v96, 0
  v_mov_b32 v97, 0
  v_mov_b32 v98, 0
  v_mov_b32 v99, 0
  v_mov_b32 v100, 0
  v_mov_b32 v101, 0
  v_mov_b32 v102, 0
  v_mov_b32 v103, 0
  v_mov_b32 v104, 0
  v_mov_b32 v105, 0
  v_mov_b32 v106, 0
  v_mov_b32 v107, 0
  v_mov_b32 v108, 0
  v_mov_b32 v109, 0
  v_mov_b32 v110, 0
  v_mov_b32 v111, 0
  v_mov_b32 v112, 0
  v_mov_b32 v113, 0
  v_mov_b32 v114, 0
  v_mov_b32 v115, 0
  v_mov_b32 v116, 0
  v_mov_b32 v117, 0
  v_mov_b32 v118, 0
  v_mov_b32 v119, 0
  v_mov_b32 v120, 0
  v_mov_b32 v121, 0
  v_mov_b32 v122, 0
  v_mov_b32 v123, 0
  v_mov_b32 v124, 0
  v_mov_b32 v125, 0
  v_mov_b32 v126, 0
  v_mov_b32 v127, 0
  v_mov_b32 v128, 0
  v_mov_b32 v129, 0
  v_mov_b32 v130, 0
  v_mov_b32 v131, 0
  v_mov_b32 v132, 0
  v_mov_b32 v133, 0
  v_mov_b32 v134, 0
  v_mov_b32 v135, 0
  v_mov_b32 v34, 0xff800000
  v_mov_b32 v35, 0
  s_mov_b32 s28, 0
L_a_A:
  s_waitcnt vmcnt(4)
  s_barrier
  s_add_u32 s34, s99, 16384
  s_add_u32 m0, s100, 32768
  s_and_b32 s34, s34, 0x7fff
  s_add_u32 s34, s34, s72
  buffer_load_dwordx4 v8, s[16:19], s34 offen offset:0  lds
  buffer_load_dwordx4 v9, s[16:19], s34 offen offset:1024  lds
  buffer_load_dwordx4 v10, s[16:19], s34 offen offset:2048  lds
  buffer_load_dwordx4 v11, s[16:19], s34 offen offset:3072  lds
  ds_read_b128 v[200:203], v16 offset:0
  ds_read_b128 v[204:207], v17 offset:0
  ds_read_b128 v[208:211], v18 offset:0
  ds_read_b128 v[212:215], v19 offset:0
  ds_read_b128 v[216:219], v20 offset:0
  ds_read_b128 v[220:223], v21 offset:0
  ds_read_b128 v[224:227], v22 offset:0
  ds_read_b128 v[228:231], v23 offset:0
  s_waitcnt lgkmcnt(7)
  v_mfma_f32_32x32x16_bf16 v[136:151], v[200:203], v[40:43], 0
  s_waitcnt lgkmcnt(6)
  v_mfma_f32_32x32x16_bf16 v[136:151], v[204:207], v[44:47], v[136:151]
  s_waitcnt lgkmcnt(5)
  v_mfma_f32_32x32x16_bf16 v[136:151], v[208:211], v[48:51], v[136:151]
  s_waitcnt lgkmcnt(4)
  v_mfma_f32_32x32x16_bf16 v[136:151], v[212:215], v[52:55], v[136:151]
  s_waitcnt lgkmcnt(3)
  v_mfma_f32_32x32x16_bf16 v[136:151], v[216:219], v[56:59], v[136:151]
  s_waitcnt lgkmcnt(2)
  v_mfma_f32_32x32x16_bf16 v[136:151], v[220:223], v[60:63], v[136:151]
  s_waitcnt lgkmcnt(1)
  v_mfma_f32_32x32x16_bf16 v[136:151], v[224:227], v[64:67], v[136:151]
  s_waitcnt lgkmcnt(0)
  v_mfma_f32_32x32x16_bf16 v[136:151], v[228:231], v[68:71], v[136:151]
  s_waitcnt vmcnt(4)
  s_barrier
  s_add_u32 s34, s99, 24576
  s_add_u32 m0, s100, 49152
  s_and_b32 s34, s34, 0x7fff
  s_add_u32 s34, s34, s72
  buffer_load_dwordx4 v8, s[16:19], s34 offen offset:0  lds
  buffer_load_dwordx4 v9, s[16:19], s34 offen offset:1024  lds
  buffer_load_dwordx4 v10, s[16:19], s34 offen offset:2048  lds
  buffer_load_dwordx4 v11, s[16:19], s34 offen offset:3072  lds
  ds_read_b128 v[200:203], v16 offset:16384
  ds_read_b128 v[204:207], v17 offset:16384
  ds_read_b128 v[208:211], v18 offset:16384
  ds_read_b128 v[212:215], v19 offset:16384
  ds_read_b128 v[216:219], v20 offset:16384
  ds_read_b128 v[220:223], v21 offset:16384
  ds_read_b128 v[224:227], v22 offset:16384
  ds_read_b128 v[228:231], v23 offset:16384
  s_waitcnt lgkmcnt(7)
  v_mfma_f32_32x32x16_bf16 v[152:167], v[200:203], v[40:43], 0
  s_waitcnt lgkmcnt(6)
  v_mfma_f32_32x32x16_bf16 v[152:167], v[204:207], v[44:47], v[152:167]
  s_waitcnt lgkmcnt(5)
  v_mfma_f32_32x32x16_bf16 v[152:167], v[208:211], v[48:51], v[152:167]
  s_waitcnt lgkmcnt(4)
  v_mfma_f32_32x32x16_bf16 v[152:167], v[212:215], v[52:55], v[152:167]
  s_waitcnt lgkmcnt(3)
  v_mfma_f32_32x32x16_bf16 v[152:167], v[216:219], v[56:59], v[152:167]
  s_waitcnt lgkmcnt(2)
  v_mfma_f32_32x32x16_bf16 v[152:167], v[220:223], v[60:63], v[152:167]
  s_waitcnt lgkmcnt(1)
  v_mfma_f32_32x32x16_bf16 v[152:167], v[224:227], v[64:67], v[152:167]
  s_waitcnt lgkmcnt(0)
  v_mfma_f32_32x32x16_bf16 v[152:167], v[228:231], v[68:71], v[152:167]
  s_waitcnt vmcnt(4)
  s_barrier
  s_add_u32 s34, s99, 0
  s_add_u32 m0, s100, 0
  s_and_b32 s34, s34, 0x7fff
  s_add_u32 s34, s34, s72
  buffer_load_dwordx4 v12, s[20:23], s34 offen offset:0  lds
  buffer_load_dwordx4 v12, s[20:23], s34 offen offset:1024  lds
  buffer_load_dwordx4 v12, s[20:23], s34 offen offset:2048  lds
  buffer_load_dwordx4 v12, s[20:23], s34 offen offset:3072  lds
  ds_read_b128 v[200:203], v16 offset:32768
  ds_read_b128 v[204:207], v17 offset:32768
  ds_read_b128 v[208:211], v18 offset:32768
  ds_read_b128 v[212:215], v19 offset:32768
  ds_read_b128 v[216:219], v20 offset:32768
  ds_read_b128 v[220:223], v21 offset:32768
  ds_read_b128 v[224:227], v22 offset:32768
  ds_read_b128 v[228:231], v23 offset:32768
  s_waitcnt lgkmcnt(7)
  v_mfma_f32_32x32x16_bf16 v[168:183], v[200:203], v[40:43], 0
  s_waitcnt lgkmcnt(6)
  v_mfma_f32_32x32x16_bf16 v[168:183], v[204:207], v[44:47], v[168:183]
  s_waitcnt lgkmcnt(5)
  v_mfma_f32_32x32x16_bf16 v[168:183], v[208:211], v[48:51], v[168:183]
  s_waitcnt lgkmcnt(4)
  v_mfma_f32_32x32x16_bf16 v[168:183], v[212:215], v[52:55], v[168:183]
  s_waitcnt lgkmcnt(3)
  v_mfma_f32_32x32x16_bf16 v[168:183], v[216:219], v[56:59], v[168:183]
  s_waitcnt lgkmcnt(2)
  v_mfma_f32_32x32x16_bf16 v[168:183], v[220:223], v[60:63], v[168:183]
  s_waitcnt lgkmcnt(1)
  v_mfma_f32_32x32x16_bf16 v[168:183], v[224:227], v[64:67], v[168:183]
  s_waitcnt lgkmcnt(0)
  v_mfma_f32_32x32x16_bf16 v[168:183], v[228:231], v[68:71], v[168:183]
  s_waitcnt vmcnt(4)
  s_barrier
  s_add_u32 s34, s99, 8192
  s_add_u32 m0, s100, 16384
  s_and_b32 s34, s34, 0x7fff
  s_add_u32 s34, s34, s72
  buffer_load_dwordx4 v12, s[20:23], s34 offen offset:0  lds
  buffer_load_dwordx4 v12, s[20:23], s34 offen offset:1024  lds
  buffer_load_dwordx4 v12, s[20:23], s34 offen offset:2048  lds
  buffer_load_dwordx4 v12, s[20:23], s34 offen offset:3072  lds
  ds_read_b128 v[200:203], v16 offset:49152
  ds_read_b128 v[204:207], v17 offset:49152
  ds_read_b128 v[208:211], v18 offset:49152
  ds_read_b128 v[212:215], v19 offset:49152
  ds_read_b128 v[216:219], v20 offset:49152
  ds_read_b128 v[220:223], v21 offset:49152
  ds_read_b128 v[224:227], v22 offset:49152
  ds_read_b128 v[228:231], v23 offset:49152
  s_waitcnt lgkmcnt(7)
  v_mfma_f32_32x32x16_bf16 v[184:199], v[200:203], v[40:43], 0
  s_waitcnt lgkmcnt(6)
  v_mfma_f32_32x32x16_bf16 v[184:199], v[204:207], v[44:47], v[184:199]
  s_waitcnt lgkmcnt(5)
  v_mfma_f32_32x32x16_bf16 v[184:199], v[208:211], v[48:51], v[184:199]
  s_waitcnt lgkmcnt(4)
  v_mfma_f32_32x32x16_bf16 v[184:199], v[212:215], v[52:55], v[184:199]
  s_waitcnt lgkmcnt(3)
  v_mfma_f32_32x32x16_bf16 v[184:199], v[216:219], v[56:59], v[184:199]
  s_waitcnt lgkmcnt(2)
  v_mfma_f32_32x32x16_bf16 v[184:199], v[220:223], v[60:63], v[184:199]
  s_waitcnt lgkmcnt(1)
  v_mfma_f32_32x32x16_bf16 v[184:199], v[224:227], v[64:67], v[184:199]
  s_waitcnt lgkmcnt(0)
  v_mfma_f32_32x32x16_bf16 v[184:199], v[228:231], v[68:71], v[184:199]
  v_max3_f32 v36, v136, v137, v138
  v_max3_f32 v37, v139, v140, v141
  v_max3_f32 v36, v36, v142, v143
  v_max3_f32 v37, v37, v144, v145
  v_max3_f32 v36, v36, v146, v147
  v_max3_f32 v37, v37, v148, v149
  v_max3_f32 v36, v36, v150, v151
  v_max3_f32 v37, v37, v152, v153
  v_max3_f32 v36, v36, v154, v155
  v_max3_f32 v37, v37, v156, v157
  v_max3_f32 v36, v36, v158, v159
  v_max3_f32 v37, v37, v160, v161
  v_max3_f32 v36, v36, v162, v163
  v_max3_f32 v37, v37, v164, v165
  v_max3_f32 v36, v36, v166, v167
  v_max3_f32 v37, v37, v168, v169
  v_max3_f32 v36, v36, v170, v171
  v_max3_f32 v37, v37, v172, v173
  v_max3_f32 v36, v36, v174, v175
  v_max3_f32 v37, v37, v176, v177
  v_max3_f32 v36, v36, v178, v179
  v_max3_f32 v37, v37, v180, v181
  v_max3_f32 v36, v36, v182, v183
  v_max3_f32 v37, v37, v184, v185
  v_max3_f32 v36, v36, v186, v187
  v_max3_f32 v37, v37, v188, v189
  v_max3_f32 v36, v36, v190, v191
  v_max3_f32 v37, v37, v192, v193
  v_max3_f32 v36, v36, v194, v195
  v_max3_f32 v37, v37, v196, v197
  v_max3_f32 v36, v36, v198, v199
  v_max_f32 v36, v36, v37
  v_mov_b32 v37, v36
s_nop 1
  v_permlane32_swap_b32 v36, v37
  v_max3_f32 v36, v36, v37, v34
  v_sub_f32 v38, v34, v36
  v_mul_f32 v38, s40, v38
  v_exp_f32 v38, v38
  v_mul_f32 v39, s40, v36
  v_sub_f32 v39, 0, v39
  v_mov_b32 v34, v36
  v_fma_f32 v136, v136, s40, v39
  v_fma_f32 v137, v137, s40, v39
  v_fma_f32 v138, v138, s40, v39
  v_fma_f32 v139, v139, s40, v39
  v_fma_f32 v140, v140, s40, v39
  v_fma_f32 v141, v141, s40, v39
  v_fma_f32 v142, v142, s40, v39
  v_fma_f32 v143, v143, s40, v39
  v_exp_f32 v136, v136
  v_exp_f32 v137, v137
  v_exp_f32 v138, v138
  v_exp_f32 v139, v139
  v_exp_f32 v140, v140
  v_exp_f32 v141, v141
  v_exp_f32 v142, v142
  v_exp_f32 v143, v143
  v_mov_b32 v1, v136
  v_mov_b32 v2, v137
  v_mov_b32 v3, v138
  v_mov_b32 v5, v139
  v_add_f32 v1, v1, v140
  v_add_f32 v2, v2, v141
  v_add_f32 v3, v3, v142
  v_add_f32 v5, v5, v143
  v_cvt_pk_bf16_f32 v136, v136, v137
  v_cvt_pk_bf16_f32 v137, v138, v139
  v_cvt_pk_bf16_f32 v138, v140, v141
  v_cvt_pk_bf16_f32 v139, v142, v143
  v_fma_f32 v144, v144, s40, v39
  v_fma_f32 v145, v145, s40, v39
  v_fma_f32 v146, v146, s40, v39
  v_fma_f32 v147, v147, s40, v39
  v_fma_f32 v148, v148, s40, v39
  v_fma_f32 v149, v149, s40, v39
  v_fma_f32 v150, v150, s40, v39
  v_fma_f32 v151, v151, s40, v39
  v_exp_f32 v144, v144
  v_exp_f32 v145, v145
  v_exp_f32 v146, v146
  v_exp_f32 v147, v147
  v_exp_f32 v148, v148
  v_exp_f32 v149, v149
  v_exp_f32 v150, v150
  v_exp_f32 v151, v151
  v_add_f32 v1, v1, v144
  v_add_f32 v2, v2, v145
  v_add_f32 v3, v3, v146
  v_add_f32 v5, v5, v147
  v_add_f32 v1, v1, v148
  v_add_f32 v2, v2, v149
  v_add_f32 v3, v3, v150
  v_add_f32 v5, v5, v151
  v_cvt_pk_bf16_f32 v140, v144, v145
  v_cvt_pk_bf16_f32 v141, v146, v147
  v_cvt_pk_bf16_f32 v142, v148, v149
  v_cvt_pk_bf16_f32 v143, v150, v151
  v_fma_f32 v152, v152, s40, v39
  v_fma_f32 v153, v153, s40, v39
  v_fma_f32 v154, v154, s40, v39
  v_fma_f32 v155, v155, s40, v39
  v_fma_f32 v156, v156, s40, v39
  v_fma_f32 v157, v157, s40, v39
  v_fma_f32 v158, v158, s40, v39
  v_fma_f32 v159, v159, s40, v39
  v_exp_f32 v152, v152
  v_exp_f32 v153, v153
  v_exp_f32 v154, v154
  v_exp_f32 v155, v155
  v_exp_f32 v156, v156
  v_exp_f32 v157, v157
  v_exp_f32 v158, v158
  v_exp_f32 v159, v159
  v_add_f32 v1, v1, v152
  v_add_f32 v2, v2, v153
  v_add_f32 v3, v3, v154
  v_add_f32 v5, v5, v155
  v_add_f32 v1, v1, v156
  v_add_f32 v2, v2, v157
  v_add_f32 v3, v3, v158
  v_add_f32 v5, v5, v159
  v_cvt_pk_bf16_f32 v144, v152, v153
  v_cvt_pk_bf16_f32 v145, v154, v155
  v_cvt_pk_bf16_f32 v146, v156, v157
  v_cvt_pk_bf16_f32 v147, v158, v159
  v_fma_f32 v160, v160, s40, v39
  v_fma_f32 v161, v161, s40, v39
  v_fma_f32 v162, v162, s40, v39
  v_fma_f32 v163, v163, s40, v39
  v_fma_f32 v164, v164, s40, v39
  v_fma_f32 v165, v165, s40, v39
  v_fma_f32 v166, v166, s40, v39
  v_fma_f32 v167, v167, s40, v39
  v_exp_f32 v160, v160
  v_exp_f32 v161, v161
  v_exp_f32 v162, v162
  v_exp_f32 v163, v163
  v_exp_f32 v164, v164
  v_exp_f32 v165, v165
  v_exp_f32 v166, v166
  v_exp_f32 v167, v167
  v_add_f32 v1, v1, v160
  v_add_f32 v2, v2, v161
  v_add_f32 v3, v3, v162
  v_add_f32 v5, v5, v163
  v_add_f32 v1, v1, v164
  v_add_f32 v2, v2, v165
  v_add_f32 v3, v3, v166
  v_add_f32 v5, v5, v167
  v_cvt_pk_bf16_f32 v148, v160, v161
  v_cvt_pk_bf16_f32 v149, v162, v163
  v_cvt_pk_bf16_f32 v150, v164, v165
  v_cvt_pk_bf16_f32 v151, v166, v167
  v_fma_f32 v168, v168, s40, v39
  v_fma_f32 v169, v169, s40, v39
  v_fma_f32 v170, v170, s40, v39
  v_fma_f32 v171, v171, s40, v39
  v_fma_f32 v172, v172, s40, v39
  v_fma_f32 v173, v173, s40, v39
  v_fma_f32 v174, v174, s40, v39
  v_fma_f32 v175, v175, s40, v39
  v_exp_f32 v168, v168
  v_exp_f32 v169, v169
  v_exp_f32 v170, v170
  v_exp_f32 v171, v171
  v_exp_f32 v172, v172
  v_exp_f32 v173, v173
  v_exp_f32 v174, v174
  v_exp_f32 v175, v175
  v_add_f32 v1, v1, v168
  v_add_f32 v2, v2, v169
  v_add_f32 v3, v3, v170
  v_add_f32 v5, v5, v171
  v_add_f32 v1, v1, v172
  v_add_f32 v2, v2, v173
  v_add_f32 v3, v3, v174
  v_add_f32 v5, v5, v175
  v_cvt_pk_bf16_f32 v152, v168, v169
  v_cvt_pk_bf16_f32 v153, v170, v171
  v_cvt_pk_bf16_f32 v154, v172, v173
  v_cvt_pk_bf16_f32 v155, v174, v175
  v_fma_f32 v176, v176, s40, v39
  v_fma_f32 v177, v177, s40, v39
  v_fma_f32 v178, v178, s40, v39
  v_fma_f32 v179, v179, s40, v39
  v_fma_f32 v180, v180, s40, v39
  v_fma_f32 v181, v181, s40, v39
  v_fma_f32 v182, v182, s40, v39
  v_fma_f32 v183, v183, s40, v39
  v_exp_f32 v176, v176
  v_exp_f32 v177, v177
  v_exp_f32 v178, v178
  v_exp_f32 v179, v179
  v_exp_f32 v180, v180
  v_exp_f32 v181, v181
  v_exp_f32 v182, v182
  v_exp_f32 v183, v183
  v_add_f32 v1, v1, v176
  v_add_f32 v2, v2, v177
  v_add_f32 v3, v3, v178
  v_add_f32 v5, v5, v179
  v_add_f32 v1, v1, v180
  v_add_f32 v2, v2, v181
  v_add_f32 v3, v3, v182
  v_add_f32 v5, v5, v183
  v_cvt_pk_bf16_f32 v156, v176, v177
  v_cvt_pk_bf16_f32 v157, v178, v179
  v_cvt_pk_bf16_f32 v158, v180, v181
  v_cvt_pk_bf16_f32 v159, v182, v183
  v_fma_f32 v184, v184, s40, v39
  v_fma_f32 v185, v185, s40, v39
  v_fma_f32 v186, v186, s40, v39
  v_fma_f32 v187, v187, s40, v39
  v_fma_f32 v188, v188, s40, v39
  v_fma_f32 v189, v189, s40, v39
  v_fma_f32 v190, v190, s40, v39
  v_fma_f32 v191, v191, s40, v39
  v_exp_f32 v184, v184
  v_exp_f32 v185, v185
  v_exp_f32 v186, v186
  v_exp_f32 v187, v187
  v_exp_f32 v188, v188
  v_exp_f32 v189, v189
  v_exp_f32 v190, v190
  v_exp_f32 v191, v191
  v_add_f32 v1, v1, v184
  v_add_f32 v2, v2, v185
  v_add_f32 v3, v3, v186
  v_add_f32 v5, v5, v187
  v_add_f32 v1, v1, v188
  v_add_f32 v2, v2, v189
  v_add_f32 v3, v3, v190
  v_add_f32 v5, v5, v191
  v_cvt_pk_bf16_f32 v160, v184, v185
  v_cvt_pk_bf16_f32 v161, v186, v187
  v_cvt_pk_bf16_f32 v162, v188, v189
  v_cvt_pk_bf16_f32 v163, v190, v191
  v_fma_f32 v192, v192, s40, v39
  v_fma_f32 v193, v193, s40, v39
  v_fma_f32 v194, v194, s40, v39
  v_fma_f32 v195, v195, s40, v39
  v_fma_f32 v196, v196, s40, v39
  v_fma_f32 v197, v197, s40, v39
  v_fma_f32 v198, v198, s40, v39
  v_fma_f32 v199, v199, s40, v39
  v_exp_f32 v192, v192
  v_exp_f32 v193, v193
  v_exp_f32 v194, v194
  v_exp_f32 v195, v195
  v_exp_f32 v196, v196
  v_exp_f32 v197, v197
  v_exp_f32 v198, v198
  v_exp_f32 v199, v199
  v_add_f32 v1, v1, v192
  v_add_f32 v2, v2, v193
  v_add_f32 v3, v3, v194
  v_add_f32 v5, v5, v195
  v_add_f32 v1, v1, v196
  v_add_f32 v2, v2, v197
  v_add_f32 v3, v3, v198
  v_add_f32 v5, v5, v199
  v_cvt_pk_bf16_f32 v164, v192, v193
  v_cvt_pk_bf16_f32 v165, v194, v195
  v_cvt_pk_bf16_f32 v166, v196, v197
  v_cvt_pk_bf16_f32 v167, v198, v199
  v_add_f32 v1, v1, v2
  v_add_f32 v3, v3, v5
  v_add_f32 v1, v1, v3
  v_fma_f32 v35, v35, v38, v1
  v_mul_f32 v72, v72, v38
  v_mul_f32 v73, v73, v38
  v_mul_f32 v74, v74, v38
  v_mul_f32 v75, v75, v38
  v_mul_f32 v76, v76, v38
  v_mul_f32 v77, v77, v38
  v_mul_f32 v78, v78, v38
  v_mul_f32 v79, v79, v38
  v_mul_f32 v80, v80, v38
  v_mul_f32 v81, v81, v38
  v_mul_f32 v82, v82, v38
  v_mul_f32 v83, v83, v38
  v_mul_f32 v84, v84, v38
  v_mul_f32 v85, v85, v38
  v_mul_f32 v86, v86, v38
  v_mul_f32 v87, v87, v38
  v_mul_f32 v88, v88, v38
  v_mul_f32 v89, v89, v38
  v_mul_f32 v90, v90, v38
  v_mul_f32 v91, v91, v38
  v_mul_f32 v92, v92, v38
  v_mul_f32 v93, v93, v38
  v_mul_f32 v94, v94, v38
  v_mul_f32 v95, v95, v38
  v_mul_f32 v96, v96, v38
  v_mul_f32 v97, v97, v38
  v_mul_f32 v98, v98, v38
  v_mul_f32 v99, v99, v38
  v_mul_f32 v100, v100, v38
  v_mul_f32 v101, v101, v38
  v_mul_f32 v102, v102, v38
  v_mul_f32 v103, v103, v38
  v_mul_f32 v104, v104, v38
  v_mul_f32 v105, v105, v38
  v_mul_f32 v106, v106, v38
  v_mul_f32 v107, v107, v38
  v_mul_f32 v108, v108, v38
  v_mul_f32 v109, v109, v38
  v_mul_f32 v110, v110, v38
  v_mul_f32 v111, v111, v38
  v_mul_f32 v112, v112, v38
  v_mul_f32 v113, v113, v38
  v_mul_f32 v114, v114, v38
  v_mul_f32 v115, v115, v38
  v_mul_f32 v116, v116, v38
  v_mul_f32 v117, v117, v38
  v_mul_f32 v118, v118, v38
  v_mul_f32 v119, v119, v38
  v_mul_f32 v120, v120, v38
  v_mul_f32 v121, v121, v38
  v_mul_f32 v122, v122, v38
  v_mul_f32 v123, v123, v38
  v_mul_f32 v124, v124, v38
  v_mul_f32 v125, v125, v38
  v_mul_f32 v126, v126, v38
  v_mul_f32 v127, v127, v38
  v_mul_f32 v128, v128, v38
  v_mul_f32 v129, v129, v38
  v_mul_f32 v130, v130, v38
  v_mul_f32 v131, v131, v38
  v_mul_f32 v132, v132, v38
  v_mul_f32 v133, v133, v38
  v_mul_f32 v134, v134, v38
  v_mul_f32 v135, v135, v38
  s_waitcnt vmcnt(4)
  s_barrier
  s_add_u32 s34, s99, 16384
  s_add_u32 m0, s100, 32768
  s_and_b32 s34, s34, 0x7fff
  s_add_u32 s34, s34, s72
  buffer_load_dwordx4 v12, s[20:23], s34 offen offset:0  lds
  buffer_load_dwordx4 v12, s[20:23], s34 offen offset:1024  lds
  buffer_load_dwordx4 v12, s[20:23], s34 offen offset:2048  lds
  buffer_load_dwordx4 v12, s[20:23], s34 offen offset:3072  lds
  ds_read_b64_tr_b16 v[200:201], v24 offset:0
  ds_read_b64_tr_b16 v[202:203], v24 offset:2048
  ds_read_b64_tr_b16 v[208:209], v25 offset:0
  ds_read_b64_tr_b16 v[210:211], v25 offset:2048
  ds_read_b64_tr_b16 v[216:217], v26 offset:0
  ds_read_b64_tr_b16 v[218:219], v26 offset:2048
  ds_read_b64_tr_b16 v[224:225], v27 offset:0
  ds_read_b64_tr_b16 v[226:227], v27 offset:2048
  ds_read_b64_tr_b16 v[204:205], v24 offset:4096
  ds_read_b64_tr_b16 v[206:207], v24 offset:6144
  ds_read_b64_tr_b16 v[212:213], v25 offset:4096
  ds_read_b64_tr_b16 v[214:215], v25 offset:6144
  ds_read_b64_tr_b16 v[220:221], v26 offset:4096
  ds_read_b64_tr_b16 v[222:223], v26 offset:6144
  ds_read_b64_tr_b16 v[228:229], v27 offset:4096
  ds_read_b64_tr_b16 v[230:231], v27 offset:6144
  s_waitcnt lgkmcnt(14)
  v_mfma_f32_32x32x16_bf16 v[72:87], v[200:203], v[136:139], v[72:87]
  s_waitcnt lgkmcnt(12)
  v_mfma_f32_32x32x16_bf16 v[88:103], v[208:211], v[136:139], v[88:103]
  s_waitcnt lgkmcnt(10)
  v_mfma_f32_32x32x16_bf16 v[104:119], v[216:219], v[136:139], v[104:119]
  s_waitcnt lgkmcnt(8)
  v_mfma_f32_32x32x16_bf16 v[120:135], v[224:227], v[136:139], v[120:135]
  s_waitcnt lgkmcnt(6)
  v_mfma_f32_32x32x16_bf16 v[72:87], v[204:207], v[140:143], v[72:87]
  s_waitcnt lgkmcnt(4)
  v_mfma_f32_32x32x16_bf16 v[88:103], v[212:215], v[140:143], v[88:103]
  s_waitcnt lgkmcnt(2)
  v_mfma_f32_32x32x16_bf16 v[104:119], v[220:223], v[140:143], v[104:119]
  s_waitcnt lgkmcnt(0)
  v_mfma_f32_32x32x16_bf16 v[120:135], v[228:231], v[140:143], v[120:135]
  s_waitcnt vmcnt(4)
  s_barrier
  s_add_u32 s34, s99, 24576
  s_add_u32 m0, s100, 49152
  s_and_b32 s34, s34, 0x7fff
  s_add_u32 s34, s34, s72
  buffer_load_dwordx4 v12, s[20:23], s34 offen offset:0  lds
  buffer_load_dwordx4 v12, s[20:23], s34 offen offset:1024  lds
  buffer_load_dwordx4 v12, s[20:23], s34 offen offset:2048  lds
  buffer_load_dwordx4 v12, s[20:23], s34 offen offset:3072  lds
  ds_read_b64_tr_b16 v[200:201], v24 offset:16384
  ds_read_b64_tr_b16 v[202:203], v24 offset:18432
  ds_read_b64_tr_b16 v[208:209], v25 offset:16384
  ds_read_b64_tr_b16 v[210:211], v25 offset:18432
  ds_read_b64_tr_b16 v[216:217], v26 offset:16384
  ds_read_b64_tr_b16 v[218:219], v26 offset:18432
  ds_read_b64_tr_b16 v[224:225], v27 offset:16384
  ds_read_b64_tr_b16 v[226:227], v27 offset:18432
  ds_read_b64_tr_b16 v[204:205], v24 offset:20480
  ds_read_b64_tr_b16 v[206:207], v24 offset:22528
  ds_read_b64_tr_b16 v[212:213], v25 offset:20480
  ds_read_b64_tr_b16 v[214:215], v25 offset:22528
  ds_read_b64_tr_b16 v[220:221], v26 offset:20480
  ds_read_b64_tr_b16 v[222:223], v26 offset:22528
  ds_read_b64_tr_b16 v[228:229], v27 offset:20480
  ds_read_b64_tr_b16 v[230:231], v27 offset:22528
  s_waitcnt lgkmcnt(14)
  v_mfma_f32_32x32x16_bf16 v[72:87], v[200:203], v[144:147], v[72:87]
  s_waitcnt lgkmcnt(12)
  v_mfma_f32_32x32x16_bf16 v[88:103], v[208:211], v[144:147], v[88:103]
  s_waitcnt lgkmcnt(10)
  v_mfma_f32_32x32x16_bf16 v[104:119], v[216:219], v[144:147], v[104:119]
  s_waitcnt lgkmcnt(8)
  v_mfma_f32_32x32x16_bf16 v[120:135], v[224:227], v[144:147], v[120:135]
  s_waitcnt lgkmcnt(6)
  v_mfma_f32_32x32x16_bf16 v[72:87], v[204:207], v[148:151], v[72:87]
  s_waitcnt lgkmcnt(4)
  v_mfma_f32_32x32x16_bf16 v[88:103], v[212:215], v[148:151], v[88:103]
  s_waitcnt lgkmcnt(2)
  v_mfma_f32_32x32x16_bf16 v[104:119], v[220:223], v[148:151], v[104:119]
  s_waitcnt lgkmcnt(0)
  v_mfma_f32_32x32x16_bf16 v[120:135], v[228:231], v[148:151], v[120:135]
  s_cmp_eq_u32 s28, 3
  s_cbranch_scc1 L_t6_A
  s_waitcnt vmcnt(4)
  s_barrier
  s_add_u32 s34, s99, 0
  s_add_u32 m0, s100, 0
  s_and_b32 s34, s34, 0x7fff
  s_add_u32 s34, s34, s73
  buffer_load_dwordx4 v8, s[16:19], s34 offen offset:0  lds
  buffer_load_dwordx4 v9, s[16:19], s34 offen offset:1024  lds
  buffer_load_dwordx4 v10, s[16:19], s34 offen offset:2048  lds
  buffer_load_dwordx4 v11, s[16:19], s34 offen offset:3072  lds
  s_branch L_u6_A
L_t6_A:
  s_waitcnt vmcnt(4)
  s_barrier
L_u6_A:
  ds_read_b64_tr_b16 v[200:201], v24 offset:32768
  ds_read_b64_tr_b16 v[202:203], v24 offset:34816
  ds_read_b64_tr_b16 v[208:209], v25 offset:32768
  ds_read_b64_tr_b16 v[210:211], v25 offset:34816
  ds_read_b64_tr_b16 v[216:217], v26 offset:32768
  ds_read_b64_tr_b16 v[218:219], v26 offset:34816
  ds_read_b64_tr_b16 v[224:225], v27 offset:32768
  ds_read_b64_tr_b16 v[226:227], v27 offset:34816
  ds_read_b64_tr_b16 v[204:205], v24 offset:36864
  ds_read_b64_tr_b16 v[206:207], v24 offset:38912
  ds_read_b64_tr_b16 v[212:213], v25 offset:36864
  ds_read_b64_tr_b16 v[214:215], v25 offset:38912
  ds_read_b64_tr_b16 v[220:221], v26 offset:36864
  ds_read_b64_tr_b16 v[222:223], v26 offset:38912
  ds_read_b64_tr_b16 v[228:229], v27 offset:36864
  ds_read_b64_tr_b16 v[230:231], v27 offset:38912
  s_waitcnt lgkmcnt(14)
  v_mfma_f32_32x32x16_bf16 v[72:87], v[200:203], v[152:155], v[72:87]
  s_waitcnt lgkmcnt(12)
  v_mfma_f32_32x32x16_bf16 v[88:103], v[208:211], v[152:155], v[88:103]
  s_waitcnt lgkmcnt(10)
  v_mfma_f32_32x32x16_bf16 v[104:119], v[216:219], v[152:155], v[104:119]
  s_waitcnt lgkmcnt(8)
  v_mfma_f32_32x32x16_bf16 v[120:135], v[224:227], v[152:155], v[120:135]
  s_waitcnt lgkmcnt(6)
  v_mfma_f32_32x32x16_bf16 v[72:87], v[204:207], v[156:159], v[72:87]
  s_waitcnt lgkmcnt(4)
  v_mfma_f32_32x32x16_bf16 v[88:103], v[212:215], v[156:159], v[88:103]
  s_waitcnt lgkmcnt(2)
  v_mfma_f32_32x32x16_bf16 v[104:119], v[220:223], v[156:159], v[104:119]
  s_waitcnt lgkmcnt(0)
  v_mfma_f32_32x32x16_bf16 v[120:135], v[228:231], v[156:159], v[120:135]
  s_cmp_eq_u32 s28, 3
  s_cbranch_scc1 L_t7_A
  s_waitcnt vmcnt(4)
  s_barrier
  s_add_u32 s34, s99, 8192
  s_add_u32 m0, s100, 16384
  s_and_b32 s34, s34, 0x7fff
  s_add_u32 s34, s34, s73
  buffer_load_dwordx4 v8, s[16:19], s34 offen offset:0  lds
  buffer_load_dwordx4 v9, s[16:19], s34 offen offset:1024  lds
  buffer_load_dwordx4 v10, s[16:19], s34 offen offset:2048  lds
  buffer_load_dwordx4 v11, s[16:19], s34 offen offset:3072  lds
  s_branch L_u7_A
L_t7_A:
  s_waitcnt vmcnt(0)
  s_barrier
L_u7_A:
  ds_read_b64_tr_b16 v[200:201], v24 offset:49152
  ds_read_b64_tr_b16 v[202:203], v24 offset:51200
  ds_read_b64_tr_b16 v[208:209], v25 offset:49152
  ds_read_b64_tr_b16 v[210:211], v25 offset:51200
  ds_read_b64_tr_b16 v[216:217], v26 offset:49152
  ds_read_b64_tr_b16 v[218:219], v26 offset:51200
  ds_read_b64_tr_b16 v[224:225], v27 offset:49152
  ds_read_b64_tr_b16 v[226:227], v27 offset:51200
  ds_read_b64_tr_b16 v[204:205], v24 offset:53248
  ds_read_b64_tr_b16 v[206:207], v24 offset:55296
  ds_read_b64_tr_b16 v[212:213], v25 offset:53248
  ds_read_b64_tr_b16 v[214:215], v25 offset:55296
  ds_read_b64_tr_b16 v[220:221], v26 offset:53248
  ds_read_b64_tr_b16 v[222:223], v26 offset:55296
  ds_read_b64_tr_b16 v[228:229], v27 offset:53248
  ds_read_b64_tr_b16 v[230:231], v27 offset:55296
  s_waitcnt lgkmcnt(14)
  v_mfma_f32_32x32x16_bf16 v[72:87], v[200:203], v[160:163], v[72:87]
  s_waitcnt lgkmcnt(12)
  v_mfma_f32_32x32x16_bf16 v[88:103], v[208:211], v[160:163], v[88:103]
  s_waitcnt lgkmcnt(10)
  v_mfma_f32_32x32x16_bf16 v[104:119], v[216:219], v[160:163], v[104:119]
  s_waitcnt lgkmcnt(8)
  v_mfma_f32_32x32x16_bf16 v[120:135], v[224:227], v[160:163], v[120:135]
  s_waitcnt lgkmcnt(6)
  v_mfma_f32_32x32x16_bf16 v[72:87], v[204:207], v[164:167], v[72:87]
  s_waitcnt lgkmcnt(4)
  v_mfma_f32_32x32x16_bf16 v[88:103], v[212:215], v[164:167], v[88:103]
  s_waitcnt lgkmcnt(2)
  v_mfma_f32_32x32x16_bf16 v[104:119], v[220:223], v[164:167], v[104:119]
  s_waitcnt lgkmcnt(0)
  v_mfma_f32_32x32x16_bf16 v[120:135], v[228:231], v[164:167], v[120:135]
  s_mov_b32 s72, s73
  s_add_u32 s73, s73, 32768
  s_and_b32 s73, s73, 0x18000
  s_add_u32 s28, s28, 1
  s_cmp_lt_u32 s28, 4
  s_cbranch_scc1 L_a_A
L_fin:
  v_mov_b32 v37, v35
s_nop 1
  v_permlane32_swap_b32 v35, v37
  v_add_f32 v35, v35, v37
  v_rcp_f32 v35, v35
  v_lshlrev_b32 v1, 4, v0
  v_mul_f32 v72, v72, v35
  v_mul_f32 v73, v73, v35
  v_mul_f32 v74, v74, v35
  v_mul_f32 v75, v75, v35
  v_mul_f32 v76, v76, v35
  v_mul_f32 v77, v77, v35
  v_mul_f32 v78, v78, v35
  v_mul_f32 v79, v79, v35
  v_cvt_pk_bf16_f32 v136, v72, v73
  v_cvt_pk_bf16_f32 v137, v74, v75
  v_cvt_pk_bf16_f32 v138, v76, v77
  v_cvt_pk_bf16_f32 v139, v78, v79
  v_mul_f32 v80, v80, v35
  v_mul_f32 v81, v81, v35
  v_mul_f32 v82, v82, v35
  v_mul_f32 v83, v83, v35
  v_mul_f32 v84, v84, v35
  v_mul_f32 v85, v85, v35
  v_mul_f32 v86, v86, v35
  v_mul_f32 v87, v87, v35
  v_cvt_pk_bf16_f32 v140, v80, v81
  v_cvt_pk_bf16_f32 v141, v82, v83
  v_cvt_pk_bf16_f32 v142, v84, v85
  v_cvt_pk_bf16_f32 v143, v86, v87
  v_mul_f32 v88, v88, v35
  v_mul_f32 v89, v89, v35
  v_mul_f32 v90, v90, v35
  v_mul_f32 v91, v91, v35
  v_mul_f32 v92, v92, v35
  v_mul_f32 v93, v93, v35
  v_mul_f32 v94, v94, v35
  v_mul_f32 v95, v95, v35
  v_cvt_pk_bf16_f32 v144, v88, v89
  v_cvt_pk_bf16_f32 v145, v90, v91
  v_cvt_pk_bf16_f32 v146, v92, v93
  v_cvt_pk_bf16_f32 v147, v94, v95
  v_mul_f32 v96, v96, v35
  v_mul_f32 v97, v97, v35
  v_mul_f32 v98, v98, v35
  v_mul_f32 v99, v99, v35
  v_mul_f32 v100, v100, v35
  v_mul_f32 v101, v101, v35
  v_mul_f32 v102, v102, v35
  v_mul_f32 v103, v103, v35
  v_cvt_pk_bf16_f32 v148, v96, v97
  v_cvt_pk_bf16_f32 v149, v98, v99
  v_cvt_pk_bf16_f32 v150, v100, v101
  v_cvt_pk_bf16_f32 v151, v102, v103
  v_mul_f32 v104, v104, v35
  v_mul_f32 v105, v105, v35
  v_mul_f32 v106, v106, v35
  v_mul_f32 v107, v107, v35
  v_mul_f32 v108, v108, v35
  v_mul_f32 v109, v109, v35
  v_mul_f32 v110, v110, v35
  v_mul_f32 v111, v111, v35
  v_cvt_pk_bf16_f32 v152, v104, v105
  v_cvt_pk_bf16_f32 v153, v106, v107
  v_cvt_pk_bf16_f32 v154, v108, v109
  v_cvt_pk_bf16_f32 v155, v110, v111
  v_mul_f32 v112, v112, v35
  v_mul_f32 v113, v113, v35
  v_mul_f32 v114, v114, v35
  v_mul_f32 v115, v115, v35
  v_mul_f32 v116, v116, v35
  v_mul_f32 v117, v117, v35
  v_mul_f32 v118, v118, v35
  v_mul_f32 v119, v119, v35
  v_cvt_pk_bf16_f32 v156, v112, v113
  v_cvt_pk_bf16_f32 v157, v114, v115
  v_cvt_pk_bf16_f32 v158, v116, v117
  v_cvt_pk_bf16_f32 v159, v118, v119
  v_mul_f32 v120, v120, v35
  v_mul_f32 v121, v121, v35
  v_mul_f32 v122, v122, v35
  v_mul_f32 v123, v123, v35
  v_mul_f32 v124, v124, v35
  v_mul_f32 v125, v125, v35
  v_mul_f32 v126, v126, v35
  v_mul_f32 v127, v127, v35
  v_cvt_pk_bf16_f32 v160, v120, v121
  v_cvt_pk_bf16_f32 v161, v122, v123
  v_cvt_pk_bf16_f32 v162, v124, v125
  v_cvt_pk_bf16_f32 v163, v126, v127
  v_mul_f32 v128, v128, v35
  v_mul_f32 v129, v129, v35
  v_mul_f32 v130, v130, v35
  v_mul_f32 v131, v131, v35
  v_mul_f32 v132, v132, v35
  v_mul_f32 v133, v133, v35
  v_mul_f32 v134, v134, v35
  v_mul_f32 v135, v135, v35
  v_cvt_pk_bf16_f32 v164, v128, v129
  v_cvt_pk_bf16_f32 v165, v130, v131
  v_cvt_pk_bf16_f32 v166, v132, v133
  v_cvt_pk_bf16_f32 v167, v134, v135
  s_mov_b32 s98, 4096
  buffer_store_dwordx4 v[136:139], v1, s[24:27], 0 offen offset:0 sc1
  buffer_store_dwordx4 v[140:143], v1, s[24:27], 0 offen offset:1024 sc1
  buffer_store_dwordx4 v[144:147], v1, s[24:27], 0 offen offset:2048 sc1
  buffer_store_dwordx4 v[148:151], v1, s[24:27], 0 offen offset:3072 sc1
  buffer_store_dwordx4 v[152:155], v1, s[24:27], s98 offen offset:0 sc1
  buffer_store_dwordx4 v[156:159], v1, s[24:27], s98 offen offset:1024 sc1
  buffer_store_dwordx4 v[160:163], v1, s[24:27], s98 offen offset:2048 sc1
  buffer_store_dwordx4 v[164:167], v1, s[24:27], s98 offen offset:3072 sc1
  s_waitcnt vmcnt(0)
  s_barrier
  s_cmp_lg_u32 s4, 0
  s_cbranch_scc1 L_pubd
  s_lshr_b32 s36, s6, 2
  s_xor_b32 s37, s7, 1
  s_lshl_b32 s35, s37, 3
  s_add_u32 s34, s36, s35
  s_lshl_b32 s34, s34, 2
  s_mov_b32 s34, 128
  v_mov_b32 v1, s34
  v_mov_b32 v2, 1
  s_mov_b64 s[96:97], exec
  s_mov_b64 exec, 1
  global_atomic_add v3, v1, v2, s[80:81] sc0 sc1
  s_waitcnt vmcnt(0)
  s_mov_b64 exec, s[96:97]
  v_readfirstlane_b32 s34, v3
s_nop 3
  s_cmp_eq_u32 s34, 511
  s_cbranch_scc0 L_pubd
  s_add_u32 s94, s60, 26214400
  s_addc_u32 s95, s61, 0
  v_mov_b32 v2, 1
  v_lshlrev_b32 v1, 7, v0
  global_store_dword v1, v2, s[94:95] sc1
  v_add_u32 v1, 0x2000, v1
  global_store_dword v1, v2, s[94:95] sc1
  v_add_u32 v1, 0x2000, v1
  global_store_dword v1, v2, s[94:95] sc1
  v_add_u32 v1, 0x2000, v1
  global_store_dword v1, v2, s[94:95] sc1
L_pubd:
  s_cmp_eq_u32 s7, 0
  s_cbranch_scc0 L_qa_end
  s_and_b32 s3, s2, 255
  s_load_dwordx2 s[44:45], s[0:1], 32
  s_load_dwordx2 s[46:47], s[0:1], 72
  s_load_dwordx2 s[48:49], s[0:1], 80
  s_load_dwordx2 s[80:81], s[0:1], 88
  s_load_dwordx2 s[60:61], s[0:1], 96
  s_and_b32 s34, s3, 7
  s_lshr_b32 s35, s3, 3
  s_lshr_b32 s7, s34, 2
  s_lshr_b32 s36, s34, 1
  s_and_b32 s36, s36, 1
  s_and_b32 s37, s34, 1
  s_and_b32 s38, s35, 3
  s_lshr_b32 s39, s35, 2
  s_lshl_b32 s6, s36, 4
  s_lshl_b32 s38, s38, 2
  s_add_u32 s6, s6, s38
  s_add_u32 s6, s6, s4
  s_lshl_b32 s5, s37, 9
  s_lshl_b32 s39, s39, 6
  s_add_u32 s5, s5, s39
  v_lshrrev_b32 v1, 3, v0
  v_and_b32 v2, 7, v0
  v_lshrrev_b32 v3, 1, v1
  v_and_b32 v3, 1, v3
  v_lshlrev_b32 v3, 2, v3
  v_xor_b32 v2, v2, v3
  v_lshlrev_b32 v2, 4, v2
  v_lshl_add_u32 v8, v1, 11, v2
  v_lshlrev_b32 v9, 4, v0
  v_lshrrev_b32 v4, 5, v0
  v_lshrrev_b32 v6, 2, v0
  v_and_b32 v6, 3, v6
  v_and_b32 v7, 3, v0
  v_lshl_add_u32 v5, v4, 2, v6
  v_lshlrev_b32 v5, 7, v5
  v_lshrrev_b32 v2, 4, v0
  v_and_b32 v2, 1, v2
  v_lshl_add_u32 v5, v2, 5, v5
  v_and_b32 v1, 1, v7
  v_lshlrev_b32 v1, 4, v1
  v_lshrrev_b32 v7, 1, v7
  v_lshl_add_u32 v1, v7, 3, v1
  v_add_u32 v5, v5, v1
  v_lshrrev_b32 v3, 1, v6
  v_lshlrev_b32 v3, 6, v3
  v_xor_b32 v1, 0, v3
  v_add_u32 v10, v5, v1
  v_xor_b32 v1, 64, v3
  v_add_u32 v11, v5, v1
  s_waitcnt lgkmcnt(0)
  s_cmp_eq_u32 s7, 0
  s_cselect_b32 s44, s44, s46
  s_cselect_b32 s45, s45, s47
  s_lshl_b32 s35, s5, 1
  s_add_u32 s44, s44, s35
  s_addc_u32 s45, s45, 0
  s_sub_u32 s36, 8388608, s35
  s_mov_b32 s8, s44
  s_and_b32 s9, s45, 0xffff
  s_mov_b32 s10, s36
  s_mov_b32 s11, 0x20000
  s_lshl_b32 s35, s6, 18
  s_lshl_b32 s36, s7, 23
  s_add_u32 s35, s35, s36
  s_add_u32 s70, s60, s35
  s_addc_u32 s71, s61, 0
  s_mov_b32 s12, s70
  s_and_b32 s13, s71, 0xffff
  s_mov_b32 s14, 262144
  s_mov_b32 s15, 0x20000
  s_lshl_b32 s35, s6, 17
  s_lshl_b32 s36, s7, 11
  s_add_u32 s35, s35, s36
  s_lshl_b32 s36, s5, 1
  s_add_u32 s35, s35, s36
  s_add_u32 s48, s48, s35
  s_addc_u32 s49, s49, 0
  s_mov_b32 s16, s48
  s_and_b32 s17, s49, 0xffff
  s_mov_b32 s18, 127104
  s_mov_b32 s19, 0x20000
  s_lshl_b32 s29, s4, 15
  s_lshl_b32 s41, s4, 11
  s_mov_b32 s43, 0
  s_lshr_b32 s34, s3, 3
  s_and_b32 s35, s34, 3
  s_lshl_b32 s35, s35, 1
  s_lshr_b32 s34, s34, 2
  s_add_u32 s34, s34, s35
  s_and_b32 s34, s34, 7
  s_mul_i32 s74, s34, 1
  s_mov_b32 s42, s74
  s_lshl_b32 s35, s42, 17
  s_add_u32 s35, s35, s29
  s_add_u32 m0, s41, 0
s_nop 0
  buffer_load_dwordx4 v8, s[8:11], s35 offen  lds
  s_add_u32 s35, s35, 16384
  s_add_u32 m0, s41, 1024
s_nop 0
  buffer_load_dwordx4 v8, s[8:11], s35 offen  lds
  s_add_u32 s43, s43, 1
  s_add_u32 s42, s43, s74
  s_and_b32 s42, s42, 7
  s_and_b32 s36, s43, 248
  s_or_b32 s42, s42, s36
  s_lshl_b32 s35, s42, 17
  s_add_u32 s35, s35, s29
  s_add_u32 m0, s41, 8192
s_nop 0
  buffer_load_dwordx4 v8, s[8:11], s35 offen  lds
  s_add_u32 s35, s35, 16384
  s_add_u32 m0, s41, 9216
s_nop 0
  buffer_load_dwordx4 v8, s[8:11], s35 offen  lds
  s_add_u32 s43, s43, 1
  s_add_u32 s42, s43, s74
  s_and_b32 s42, s42, 7
  s_and_b32 s36, s43, 248
  s_or_b32 s42, s42, s36
  s_lshl_b32 s35, s42, 17
  s_add_u32 s35, s35, s29
  s_add_u32 m0, s41, 16384
s_nop 0
  buffer_load_dwordx4 v8, s[8:11], s35 offen  lds
  s_add_u32 s35, s35, 16384
  s_add_u32 m0, s41, 17408
s_nop 0
  buffer_load_dwordx4 v8, s[8:11], s35 offen  lds
  s_add_u32 s43, s43, 1
  s_add_u32 s42, s43, s74
  s_and_b32 s42, s42, 7
  s_and_b32 s36, s43, 248
  s_or_b32 s42, s42, s36
  s_lshl_b32 s35, s42, 17
  s_add_u32 s35, s35, s29
  s_add_u32 m0, s41, 24576
s_nop 0
  buffer_load_dwordx4 v8, s[8:11], s35 offen  lds
  s_add_u32 s35, s35, 16384
  s_add_u32 m0, s41, 25600
s_nop 0
  buffer_load_dwordx4 v8, s[8:11], s35 offen  lds
  s_add_u32 s43, s43, 1
  s_add_u32 s42, s43, s74
  s_and_b32 s42, s42, 7
  s_and_b32 s36, s43, 248
  s_or_b32 s42, s42, s36
  s_lshl_b32 s35, s42, 17
  s_add_u32 s35, s35, s29
  s_add_u32 m0, s41, 32768
s_nop 0
  buffer_load_dwordx4 v8, s[8:11], s35 offen  lds
  s_add_u32 s35, s35, 16384
  s_add_u32 m0, s41, 33792
s_nop 0
  buffer_load_dwordx4 v8, s[8:11], s35 offen  lds
  s_add_u32 s43, s43, 1
  s_add_u32 s42, s43, s74
  s_and_b32 s42, s42, 7
  s_and_b32 s36, s43, 248
  s_or_b32 s42, s42, s36
  s_lshl_b32 s35, s42, 17
  s_add_u32 s35, s35, s29
  s_add_u32 m0, s41, 40960
s_nop 0
  buffer_load_dwordx4 v8, s[8:11], s35 offen  lds
  s_add_u32 s35, s35, 16384
  s_add_u32 m0, s41, 41984
s_nop 0
  buffer_load_dwordx4 v8, s[8:11], s35 offen  lds
  s_add_u32 s43, s43, 1
  s_add_u32 s42, s43, s74
  s_and_b32 s42, s42, 7
  s_and_b32 s36, s43, 248
  s_or_b32 s42, s42, s36
  s_lshl_b32 s35, s42, 17
  s_add_u32 s35, s35, s29
  s_add_u32 m0, s41, 49152
s_nop 0
  buffer_load_dwordx4 v8, s[8:11], s35 offen  lds
  s_add_u32 s35, s35, 16384
  s_add_u32 m0, s41, 50176
s_nop 0
  buffer_load_dwordx4 v8, s[8:11], s35 offen  lds
  s_add_u32 s43, s43, 1
  s_add_u32 s42, s43, s74
  s_and_b32 s42, s42, 7
  s_and_b32 s36, s43, 248
  s_or_b32 s42, s42, s36
  s_lshl_b32 s35, s42, 17
  s_add_u32 s35, s35, s29
  s_add_u32 m0, s41, 57344
s_nop 0
  buffer_load_dwordx4 v8, s[8:11], s35 offen  lds
  s_add_u32 s35, s35, 16384
  s_add_u32 m0, s41, 58368
s_nop 0
  buffer_load_dwordx4 v8, s[8:11], s35 offen  lds
  s_add_u32 s43, s43, 1
  s_add_u32 s42, s43, s74
  s_and_b32 s42, s42, 7
  s_and_b32 s36, s43, 248
  s_or_b32 s42, s42, s36
  s_mov_b32 s43, 0
  s_mov_b32 s42, s74
  s_lshr_b32 s34, s3, 3
  s_and_b32 s34, s34, 3
  s_mul_i32 s34, s34, 512
  s_mul_i32 s35, s4, 128
  s_add_u32 s34, s34, s35
  v_add_u32 v1, s34, v0
  v_lshlrev_b32 v1, 11, v1
  s_mov_b32 s35, 0
  buffer_load_dword v240, v1, s[8:11], s35 offen
  s_mov_b32 s35, 131072
  buffer_load_dword v241, v1, s[8:11], s35 offen
  s_add_u32 s94, s60, 26214400
  s_addc_u32 s95, s61, 0
  s_lshl_b32 s34, s3, 7
  v_mov_b32 v1, s34
  s_cmp_lg_u32 s4, 0
  s_cbranch_scc1 L_rdy
L_wait:
  global_load_dword v2, v1, s[94:95] sc1
  s_waitcnt vmcnt(0)
  v_readfirstlane_b32 s34, v2
s_nop 3
  s_cmp_eq_u32 s34, 1
  s_cbranch_scc1 L_rdy
  s_sleep 4
  s_branch L_wait
L_rdy:
  s_waitcnt vmcnt(0)
  s_barrier
  s_lshl_b32 s30, s42, 12
  buffer_load_dwordx4 v[80:83], v9, s[12:15], s30 offen offset:0 sc1
  buffer_load_dwordx4 v[84:87], v9, s[12:15], s30 offen offset:1024 sc1
  buffer_load_dwordx4 v[88:91], v9, s[12:15], s30 offen offset:2048 sc1
  buffer_load_dwordx4 v[92:95], v9, s[12:15], s30 offen offset:3072 sc1
  s_add_u32 s43, s43, 1
  s_add_u32 s42, s43, s74
  s_and_b32 s42, s42, 7
  s_and_b32 s36, s43, 248
  s_or_b32 s42, s42, s36
  s_lshl_b32 s30, s42, 12
  buffer_load_dwordx4 v[96:99], v9, s[12:15], s30 offen offset:0 sc1
  buffer_load_dwordx4 v[100:103], v9, s[12:15], s30 offen offset:1024 sc1
  buffer_load_dwordx4 v[104:107], v9, s[12:15], s30 offen offset:2048 sc1
  buffer_load_dwordx4 v[108:111], v9, s[12:15], s30 offen offset:3072 sc1
  s_add_u32 s43, s43, 1
  s_add_u32 s42, s43, s74
  s_and_b32 s42, s42, 7
  s_and_b32 s36, s43, 248
  s_or_b32 s42, s42, s36
  s_lshl_b32 s30, s42, 12
  buffer_load_dwordx4 v[112:115], v9, s[12:15], s30 offen offset:0 sc1
  buffer_load_dwordx4 v[116:119], v9, s[12:15], s30 offen offset:1024 sc1
  buffer_load_dwordx4 v[120:123], v9, s[12:15], s30 offen offset:2048 sc1
  buffer_load_dwordx4 v[124:127], v9, s[12:15], s30 offen offset:3072 sc1
  s_add_u32 s43, s43, 1
  s_add_u32 s42, s43, s74
  s_and_b32 s42, s42, 7
  s_and_b32 s36, s43, 248
  s_or_b32 s42, s42, s36
  s_lshl_b32 s30, s42, 12
  buffer_load_dwordx4 v[128:131], v9, s[12:15], s30 offen offset:0 sc1
  buffer_load_dwordx4 v[132:135], v9, s[12:15], s30 offen offset:1024 sc1
  buffer_load_dwordx4 v[136:139], v9, s[12:15], s30 offen offset:2048 sc1
  buffer_load_dwordx4 v[140:143], v9, s[12:15], s30 offen offset:3072 sc1
  s_add_u32 s43, s43, 1
  s_add_u32 s42, s43, s74
  s_and_b32 s42, s42, 7
  s_and_b32 s36, s43, 248
  s_or_b32 s42, s42, s36
  s_lshl_b32 s30, s42, 12
  buffer_load_dwordx4 v[144:147], v9, s[12:15], s30 offen offset:0 sc1
  buffer_load_dwordx4 v[148:151], v9, s[12:15], s30 offen offset:1024 sc1
  buffer_load_dwordx4 v[152:155], v9, s[12:15], s30 offen offset:2048 sc1
  buffer_load_dwordx4 v[156:159], v9, s[12:15], s30 offen offset:3072 sc1
  s_add_u32 s43, s43, 1
  s_add_u32 s42, s43, s74
  s_and_b32 s42, s42, 7
  s_and_b32 s36, s43, 248
  s_or_b32 s42, s42, s36
  s_lshl_b32 s30, s42, 12
  buffer_load_dwordx4 v[160:163], v9, s[12:15], s30 offen offset:0 sc1
  buffer_load_dwordx4 v[164:167], v9, s[12:15], s30 offen offset:1024 sc1
  buffer_load_dwordx4 v[168:171], v9, s[12:15], s30 offen offset:2048 sc1
  buffer_load_dwordx4 v[172:175], v9, s[12:15], s30 offen offset:3072 sc1
  s_add_u32 s43, s43, 1
  s_add_u32 s42, s43, s74
  s_and_b32 s42, s42, 7
  s_and_b32 s36, s43, 248
  s_or_b32 s42, s42, s36
  s_lshl_b32 s30, s42, 12
  buffer_load_dwordx4 v[176:179], v9, s[12:15], s30 offen offset:0 sc1
  buffer_load_dwordx4 v[180:183], v9, s[12:15], s30 offen offset:1024 sc1
  buffer_load_dwordx4 v[184:187], v9, s[12:15], s30 offen offset:2048 sc1
  buffer_load_dwordx4 v[188:191], v9, s[12:15], s30 offen offset:3072 sc1
  s_add_u32 s43, s43, 1
  s_add_u32 s42, s43, s74
  s_and_b32 s42, s42, 7
  s_and_b32 s36, s43, 248
  s_or_b32 s42, s42, s36
  s_lshl_b32 s30, s42, 12
  buffer_load_dwordx4 v[192:195], v9, s[12:15], s30 offen offset:0 sc1
  buffer_load_dwordx4 v[196:199], v9, s[12:15], s30 offen offset:1024 sc1
  buffer_load_dwordx4 v[200:203], v9, s[12:15], s30 offen offset:2048 sc1
  buffer_load_dwordx4 v[204:207], v9, s[12:15], s30 offen offset:3072 sc1
  s_add_u32 s43, s43, 1
  s_add_u32 s42, s43, s74
  s_and_b32 s42, s42, 7
  s_and_b32 s36, s43, 248
  s_or_b32 s42, s42, s36
  v_mov_b32 v16, 0
  v_mov_b32 v17, 0
  v_mov_b32 v18, 0
  v_mov_b32 v19, 0
  v_mov_b32 v20, 0
  v_mov_b32 v21, 0
  v_mov_b32 v22, 0
  v_mov_b32 v23, 0
  v_mov_b32 v24, 0
  v_mov_b32 v25, 0
  v_mov_b32 v26, 0
  v_mov_b32 v27, 0
  v_mov_b32 v28, 0
  v_mov_b32 v29, 0
  v_mov_b32 v30, 0
  v_mov_b32 v31, 0
  v_mov_b32 v32, 0
  v_mov_b32 v33, 0
  v_mov_b32 v34, 0
  v_mov_b32 v35, 0
  v_mov_b32 v36, 0
  v_mov_b32 v37, 0
  v_mov_b32 v38, 0
  v_mov_b32 v39, 0
  v_mov_b32 v40, 0
  v_mov_b32 v41, 0
  v_mov_b32 v42, 0
  v_mov_b32 v43, 0
  v_mov_b32 v44, 0
  v_mov_b32 v45, 0
  v_mov_b32 v46, 0
  v_mov_b32 v47, 0
  s_waitcnt vmcnt(28)
  s_barrier
  ds_read_b64_tr_b16 v[48:49], v10 offset:0
  ds_read_b64_tr_b16 v[50:51], v10 offset:1024
  ds_read_b64_tr_b16 v[52:53], v11 offset:0
  ds_read_b64_tr_b16 v[54:55], v11 offset:1024
  ds_read_b64_tr_b16 v[56:57], v10 offset:2048
  ds_read_b64_tr_b16 v[58:59], v10 offset:3072
  ds_read_b64_tr_b16 v[60:61], v11 offset:2048
  ds_read_b64_tr_b16 v[62:63], v11 offset:3072
  s_mov_b32 s28, 7
L_o:
  s_waitcnt lgkmcnt(6)
  v_mfma_f32_32x32x16_bf16 v[16:31], v[48:51], v[80:83], v[16:31]
  ds_read_b64_tr_b16 v[64:65], v10 offset:4096
  ds_read_b64_tr_b16 v[66:67], v10 offset:5120
  ds_read_b64_tr_b16 v[68:69], v11 offset:4096
  ds_read_b64_tr_b16 v[70:71], v11 offset:5120
  s_waitcnt lgkmcnt(8)
  v_mfma_f32_32x32x16_bf16 v[32:47], v[52:55], v[80:83], v[32:47]
  ds_read_b64_tr_b16 v[72:73], v10 offset:6144
  ds_read_b64_tr_b16 v[74:75], v10 offset:7168
  ds_read_b64_tr_b16 v[76:77], v11 offset:6144
  ds_read_b64_tr_b16 v[78:79], v11 offset:7168
  s_waitcnt lgkmcnt(10)
  v_mfma_f32_32x32x16_bf16 v[16:31], v[56:59], v[84:87], v[16:31]
  s_waitcnt lgkmcnt(8)
  v_mfma_f32_32x32x16_bf16 v[32:47], v[60:63], v[84:87], v[32:47]
  s_waitcnt vmcnt(18) lgkmcnt(0)
  s_barrier
  v_mfma_f32_32x32x16_bf16 v[16:31], v[64:67], v[88:91], v[16:31]
  ds_read_b64_tr_b16 v[208:209], v10 offset:8192
  ds_read_b64_tr_b16 v[210:211], v10 offset:9216
  s_lshl_b32 s30, s42, 12
  buffer_load_dwordx4 v[80:83], v9, s[12:15], s30 offen offset:0 sc1
  buffer_load_dwordx4 v[84:87], v9, s[12:15], s30 offen offset:1024 sc1
  s_lshl_b32 s35, s42, 17
  s_add_u32 s35, s35, s29
  s_add_u32 m0, s41, 0
s_nop 0
  buffer_load_dwordx4 v8, s[8:11], s35 offen  lds
  v_mfma_f32_32x32x16_bf16 v[32:47], v[68:71], v[88:91], v[32:47]
  ds_read_b64_tr_b16 v[212:213], v11 offset:8192
  ds_read_b64_tr_b16 v[214:215], v11 offset:9216
  buffer_load_dwordx4 v[88:91], v9, s[12:15], s30 offen offset:2048 sc1
  v_mfma_f32_32x32x16_bf16 v[16:31], v[72:75], v[92:95], v[16:31]
  ds_read_b64_tr_b16 v[216:217], v10 offset:10240
  ds_read_b64_tr_b16 v[218:219], v10 offset:11264
  v_mfma_f32_32x32x16_bf16 v[32:47], v[76:79], v[92:95], v[32:47]
  ds_read_b64_tr_b16 v[220:221], v11 offset:10240
  ds_read_b64_tr_b16 v[222:223], v11 offset:11264
  buffer_load_dwordx4 v[92:95], v9, s[12:15], s30 offen offset:3072 sc1
  s_add_u32 s35, s35, 16384
  s_add_u32 m0, s41, 1024
s_nop 0
  buffer_load_dwordx4 v8, s[8:11], s35 offen  lds
  s_add_u32 s43, s43, 1
  s_add_u32 s42, s43, s74
  s_and_b32 s42, s42, 7
  s_and_b32 s36, s43, 248
  s_or_b32 s42, s42, s36
  s_waitcnt lgkmcnt(6)
  v_mfma_f32_32x32x16_bf16 v[16:31], v[208:211], v[96:99], v[16:31]
  ds_read_b64_tr_b16 v[224:225], v10 offset:12288
  ds_read_b64_tr_b16 v[226:227], v10 offset:13312
  ds_read_b64_tr_b16 v[228:229], v11 offset:12288
  ds_read_b64_tr_b16 v[230:231], v11 offset:13312
  s_waitcnt lgkmcnt(8)
  v_mfma_f32_32x32x16_bf16 v[32:47], v[212:215], v[96:99], v[32:47]
  ds_read_b64_tr_b16 v[232:233], v10 offset:14336
  ds_read_b64_tr_b16 v[234:235], v10 offset:15360
  ds_read_b64_tr_b16 v[236:237], v11 offset:14336
  ds_read_b64_tr_b16 v[238:239], v11 offset:15360
  s_waitcnt lgkmcnt(10)
  v_mfma_f32_32x32x16_bf16 v[16:31], v[216:219], v[100:103], v[16:31]
  s_waitcnt lgkmcnt(8)
  v_mfma_f32_32x32x16_bf16 v[32:47], v[220:223], v[100:103], v[32:47]
  s_waitcnt vmcnt(18) lgkmcnt(0)
  s_barrier
  v_mfma_f32_32x32x16_bf16 v[16:31], v[224:227], v[104:107], v[16:31]
  ds_read_b64_tr_b16 v[48:49], v10 offset:16384
  ds_read_b64_tr_b16 v[50:51], v10 offset:17408
  s_lshl_b32 s30, s42, 12
  buffer_load_dwordx4 v[96:99], v9, s[12:15], s30 offen offset:0 sc1
  buffer_load_dwordx4 v[100:103], v9, s[12:15], s30 offen offset:1024 sc1
  s_lshl_b32 s35, s42, 17
  s_add_u32 s35, s35, s29
  s_add_u32 m0, s41, 8192
s_nop 0
  buffer_load_dwordx4 v8, s[8:11], s35 offen  lds
  v_mfma_f32_32x32x16_bf16 v[32:47], v[228:231], v[104:107], v[32:47]
  ds_read_b64_tr_b16 v[52:53], v11 offset:16384
  ds_read_b64_tr_b16 v[54:55], v11 offset:17408
  buffer_load_dwordx4 v[104:107], v9, s[12:15], s30 offen offset:2048 sc1
  v_mfma_f32_32x32x16_bf16 v[16:31], v[232:235], v[108:111], v[16:31]
  ds_read_b64_tr_b16 v[56:57], v10 offset:18432
  ds_read_b64_tr_b16 v[58:59], v10 offset:19456
  v_mfma_f32_32x32x16_bf16 v[32:47], v[236:239], v[108:111], v[32:47]
  ds_read_b64_tr_b16 v[60:61], v11 offset:18432
  ds_read_b64_tr_b16 v[62:63], v11 offset:19456
  buffer_load_dwordx4 v[108:111], v9, s[12:15], s30 offen offset:3072 sc1
  s_add_u32 s35, s35, 16384
  s_add_u32 m0, s41, 9216
s_nop 0
  buffer_load_dwordx4 v8, s[8:11], s35 offen  lds
  s_add_u32 s43, s43, 1
  s_add_u32 s42, s43, s74
  s_and_b32 s42, s42, 7
  s_and_b32 s36, s43, 248
  s_or_b32 s42, s42, s36
  s_waitcnt lgkmcnt(6)
  v_mfma_f32_32x32x16_bf16 v[16:31], v[48:51], v[112:115], v[16:31]
  ds_read_b64_tr_b16 v[64:65], v10 offset:20480
  ds_read_b64_tr_b16 v[66:67], v10 offset:21504
  ds_read_b64_tr_b16 v[68:69], v11 offset:20480
  ds_read_b64_tr_b16 v[70:71], v11 offset:21504
  s_waitcnt lgkmcnt(8)
  v_mfma_f32_32x32x16_bf16 v[32:47], v[52:55], v[112:115], v[32:47]
  ds_read_b64_tr_b16 v[72:73], v10 offset:22528
  ds_read_b64_tr_b16 v[74:75], v10 offset:23552
  ds_read_b64_tr_b16 v[76:77], v11 offset:22528
  ds_read_b64_tr_b16 v[78:79], v11 offset:23552
  s_waitcnt lgkmcnt(10)
  v_mfma_f32_32x32x16_bf16 v[16:31], v[56:59], v[116:119], v[16:31]
  s_waitcnt lgkmcnt(8)
  v_mfma_f32_32x32x16_bf16 v[32:47], v[60:63], v[116:119], v[32:47]
  s_waitcnt vmcnt(18) lgkmcnt(0)
  s_barrier
  v_mfma_f32_32x32x16_bf16 v[16:31], v[64:67], v[120:123], v[16:31]
  ds_read_b64_tr_b16 v[208:209], v10 offset:24576
  ds_read_b64_tr_b16 v[210:211], v10 offset:25600
  s_lshl_b32 s30, s42, 12
  buffer_load_dwordx4 v[112:115], v9, s[12:15], s30 offen offset:0 sc1
  buffer_load_dwordx4 v[116:119], v9, s[12:15], s30 offen offset:1024 sc1
  s_lshl_b32 s35, s42, 17
  s_add_u32 s35, s35, s29
  s_add_u32 m0, s41, 16384
s_nop 0
  buffer_load_dwordx4 v8, s[8:11], s35 offen  lds
  v_mfma_f32_32x32x16_bf16 v[32:47], v[68:71], v[120:123], v[32:47]
  ds_read_b64_tr_b16 v[212:213], v11 offset:24576
  ds_read_b64_tr_b16 v[214:215], v11 offset:25600
  buffer_load_dwordx4 v[120:123], v9, s[12:15], s30 offen offset:2048 sc1
  v_mfma_f32_32x32x16_bf16 v[16:31], v[72:75], v[124:127], v[16:31]
  ds_read_b64_tr_b16 v[216:217], v10 offset:26624
  ds_read_b64_tr_b16 v[218:219], v10 offset:27648
  v_mfma_f32_32x32x16_bf16 v[32:47], v[76:79], v[124:127], v[32:47]
  ds_read_b64_tr_b16 v[220:221], v11 offset:26624
  ds_read_b64_tr_b16 v[222:223], v11 offset:27648
  buffer_load_dwordx4 v[124:127], v9, s[12:15], s30 offen offset:3072 sc1
  s_add_u32 s35, s35, 16384
  s_add_u32 m0, s41, 17408
s_nop 0
  buffer_load_dwordx4 v8, s[8:11], s35 offen  lds
  s_add_u32 s43, s43, 1
  s_add_u32 s42, s43, s74
  s_and_b32 s42, s42, 7
  s_and_b32 s36, s43, 248
  s_or_b32 s42, s42, s36
  s_waitcnt lgkmcnt(6)
  v_mfma_f32_32x32x16_bf16 v[16:31], v[208:211], v[128:131], v[16:31]
  ds_read_b64_tr_b16 v[224:225], v10 offset:28672
  ds_read_b64_tr_b16 v[226:227], v10 offset:29696
  ds_read_b64_tr_b16 v[228:229], v11 offset:28672
  ds_read_b64_tr_b16 v[230:231], v11 offset:29696
  s_waitcnt lgkmcnt(8)
  v_mfma_f32_32x32x16_bf16 v[32:47], v[212:215], v[128:131], v[32:47]
  ds_read_b64_tr_b16 v[232:233], v10 offset:30720
  ds_read_b64_tr_b16 v[234:235], v10 offset:31744
  ds_read_b64_tr_b16 v[236:237], v11 offset:30720
  ds_read_b64_tr_b16 v[238:239], v11 offset:31744
  s_waitcnt lgkmcnt(10)
  v_mfma_f32_32x32x16_bf16 v[16:31], v[216:219], v[132:135], v[16:31]
  s_waitcnt lgkmcnt(8)
  v_mfma_f32_32x32x16_bf16 v[32:47], v[220:223], v[132:135], v[32:47]
  s_waitcnt vmcnt(18) lgkmcnt(0)
  s_barrier
  v_mfma_f32_32x32x16_bf16 v[16:31], v[224:227], v[136:139], v[16:31]
  ds_read_b64_tr_b16 v[48:49], v10 offset:32768
  ds_read_b64_tr_b16 v[50:51], v10 offset:33792
  s_lshl_b32 s30, s42, 12
  buffer_load_dwordx4 v[128:131], v9, s[12:15], s30 offen offset:0 sc1
  buffer_load_dwordx4 v[132:135], v9, s[12:15], s30 offen offset:1024 sc1
  s_lshl_b32 s35, s42, 17
  s_add_u32 s35, s35, s29
  s_add_u32 m0, s41, 24576
s_nop 0
  buffer_load_dwordx4 v8, s[8:11], s35 offen  lds
  v_mfma_f32_32x32x16_bf16 v[32:47], v[228:231], v[136:139], v[32:47]
  ds_read_b64_tr_b16 v[52:53], v11 offset:32768
  ds_read_b64_tr_b16 v[54:55], v11 offset:33792
  buffer_load_dwordx4 v[136:139], v9, s[12:15], s30 offen offset:2048 sc1
  v_mfma_f32_32x32x16_bf16 v[16:31], v[232:235], v[140:143], v[16:31]
  ds_read_b64_tr_b16 v[56:57], v10 offset:34816
  ds_read_b64_tr_b16 v[58:59], v10 offset:35840
  v_mfma_f32_32x32x16_bf16 v[32:47], v[236:239], v[140:143], v[32:47]
  ds_read_b64_tr_b16 v[60:61], v11 offset:34816
  ds_read_b64_tr_b16 v[62:63], v11 offset:35840
  buffer_load_dwordx4 v[140:143], v9, s[12:15], s30 offen offset:3072 sc1
  s_add_u32 s35, s35, 16384
  s_add_u32 m0, s41, 25600
s_nop 0
  buffer_load_dwordx4 v8, s[8:11], s35 offen  lds
  s_add_u32 s43, s43, 1
  s_add_u32 s42, s43, s74
  s_and_b32 s42, s42, 7
  s_and_b32 s36, s43, 248
  s_or_b32 s42, s42, s36
  s_waitcnt lgkmcnt(6)
  v_mfma_f32_32x32x16_bf16 v[16:31], v[48:51], v[144:147], v[16:31]
  ds_read_b64_tr_b16 v[64:65], v10 offset:36864
  ds_read_b64_tr_b16 v[66:67], v10 offset:37888
  ds_read_b64_tr_b16 v[68:69], v11 offset:36864
  ds_read_b64_tr_b16 v[70:71], v11 offset:37888
  s_waitcnt lgkmcnt(8)
  v_mfma_f32_32x32x16_bf16 v[32:47], v[52:55], v[144:147], v[32:47]
  ds_read_b64_tr_b16 v[72:73], v10 offset:38912
  ds_read_b64_tr_b16 v[74:75], v10 offset:39936
  ds_read_b64_tr_b16 v[76:77], v11 offset:38912
  ds_read_b64_tr_b16 v[78:79], v11 offset:39936
  s_waitcnt lgkmcnt(10)
  v_mfma_f32_32x32x16_bf16 v[16:31], v[56:59], v[148:151], v[16:31]
  s_waitcnt lgkmcnt(8)
  v_mfma_f32_32x32x16_bf16 v[32:47], v[60:63], v[148:151], v[32:47]
  s_waitcnt vmcnt(18) lgkmcnt(0)
  s_barrier
  v_mfma_f32_32x32x16_bf16 v[16:31], v[64:67], v[152:155], v[16:31]
  ds_read_b64_tr_b16 v[208:209], v10 offset:40960
  ds_read_b64_tr_b16 v[210:211], v10 offset:41984
  s_lshl_b32 s30, s42, 12
  buffer_load_dwordx4 v[144:147], v9, s[12:15], s30 offen offset:0 sc1
  buffer_load_dwordx4 v[148:151], v9, s[12:15], s30 offen offset:1024 sc1
  s_lshl_b32 s35, s42, 17
  s_add_u32 s35, s35, s29
  s_add_u32 m0, s41, 32768
s_nop 0
  buffer_load_dwordx4 v8, s[8:11], s35 offen  lds
  v_mfma_f32_32x32x16_bf16 v[32:47], v[68:71], v[152:155], v[32:47]
  ds_read_b64_tr_b16 v[212:213], v11 offset:40960
  ds_read_b64_tr_b16 v[214:215], v11 offset:41984
  buffer_load_dwordx4 v[152:155], v9, s[12:15], s30 offen offset:2048 sc1
  v_mfma_f32_32x32x16_bf16 v[16:31], v[72:75], v[156:159], v[16:31]
  ds_read_b64_tr_b16 v[216:217], v10 offset:43008
  ds_read_b64_tr_b16 v[218:219], v10 offset:44032
  v_mfma_f32_32x32x16_bf16 v[32:47], v[76:79], v[156:159], v[32:47]
  ds_read_b64_tr_b16 v[220:221], v11 offset:43008
  ds_read_b64_tr_b16 v[222:223], v11 offset:44032
  buffer_load_dwordx4 v[156:159], v9, s[12:15], s30 offen offset:3072 sc1
  s_add_u32 s35, s35, 16384
  s_add_u32 m0, s41, 33792
s_nop 0
  buffer_load_dwordx4 v8, s[8:11], s35 offen  lds
  s_add_u32 s43, s43, 1
  s_add_u32 s42, s43, s74
  s_and_b32 s42, s42, 7
  s_and_b32 s36, s43, 248
  s_or_b32 s42, s42, s36
  s_waitcnt lgkmcnt(6)
  v_mfma_f32_32x32x16_bf16 v[16:31], v[208:211], v[160:163], v[16:31]
  ds_read_b64_tr_b16 v[224:225], v10 offset:45056
  ds_read_b64_tr_b16 v[226:227], v10 offset:46080
  ds_read_b64_tr_b16 v[228:229], v11 offset:45056
  ds_read_b64_tr_b16 v[230:231], v11 offset:46080
  s_waitcnt lgkmcnt(8)
  v_mfma_f32_32x32x16_bf16 v[32:47], v[212:215], v[160:163], v[32:47]
  ds_read_b64_tr_b16 v[232:233], v10 offset:47104
  ds_read_b64_tr_b16 v[234:235], v10 offset:48128
  ds_read_b64_tr_b16 v[236:237], v11 offset:47104
  ds_read_b64_tr_b16 v[238:239], v11 offset:48128
  s_waitcnt lgkmcnt(10)
  v_mfma_f32_32x32x16_bf16 v[16:31], v[216:219], v[164:167], v[16:31]
  s_waitcnt lgkmcnt(8)
  v_mfma_f32_32x32x16_bf16 v[32:47], v[220:223], v[164:167], v[32:47]
  s_waitcnt vmcnt(18) lgkmcnt(0)
  s_barrier
  v_mfma_f32_32x32x16_bf16 v[16:31], v[224:227], v[168:171], v[16:31]
  ds_read_b64_tr_b16 v[48:49], v10 offset:49152
  ds_read_b64_tr_b16 v[50:51], v10 offset:50176
  s_lshl_b32 s30, s42, 12
  buffer_load_dwordx4 v[160:163], v9, s[12:15], s30 offen offset:0 sc1
  buffer_load_dwordx4 v[164:167], v9, s[12:15], s30 offen offset:1024 sc1
  s_lshl_b32 s35, s42, 17
  s_add_u32 s35, s35, s29
  s_add_u32 m0, s41, 40960
s_nop 0
  buffer_load_dwordx4 v8, s[8:11], s35 offen  lds
  v_mfma_f32_32x32x16_bf16 v[32:47], v[228:231], v[168:171], v[32:47]
  ds_read_b64_tr_b16 v[52:53], v11 offset:49152
  ds_read_b64_tr_b16 v[54:55], v11 offset:50176
  buffer_load_dwordx4 v[168:171], v9, s[12:15], s30 offen offset:2048 sc1
  v_mfma_f32_32x32x16_bf16 v[16:31], v[232:235], v[172:175], v[16:31]
  ds_read_b64_tr_b16 v[56:57], v10 offset:51200
  ds_read_b64_tr_b16 v[58:59], v10 offset:52224
  v_mfma_f32_32x32x16_bf16 v[32:47], v[236:239], v[172:175], v[32:47]
  ds_read_b64_tr_b16 v[60:61], v11 offset:51200
  ds_read_b64_tr_b16 v[62:63], v11 offset:52224
  buffer_load_dwordx4 v[172:175], v9, s[12:15], s30 offen offset:3072 sc1
  s_add_u32 s35, s35, 16384
  s_add_u32 m0, s41, 41984
s_nop 0
  buffer_load_dwordx4 v8, s[8:11], s35 offen  lds
  s_add_u32 s43, s43, 1
  s_add_u32 s42, s43, s74
  s_and_b32 s42, s42, 7
  s_and_b32 s36, s43, 248
  s_or_b32 s42, s42, s36
  s_waitcnt lgkmcnt(6)
  v_mfma_f32_32x32x16_bf16 v[16:31], v[48:51], v[176:179], v[16:31]
  ds_read_b64_tr_b16 v[64:65], v10 offset:53248
  ds_read_b64_tr_b16 v[66:67], v10 offset:54272
  ds_read_b64_tr_b16 v[68:69], v11 offset:53248
  ds_read_b64_tr_b16 v[70:71], v11 offset:54272
  s_waitcnt lgkmcnt(8)
  v_mfma_f32_32x32x16_bf16 v[32:47], v[52:55], v[176:179], v[32:47]
  ds_read_b64_tr_b16 v[72:73], v10 offset:55296
  ds_read_b64_tr_b16 v[74:75], v10 offset:56320
  ds_read_b64_tr_b16 v[76:77], v11 offset:55296
  ds_read_b64_tr_b16 v[78:79], v11 offset:56320
  s_waitcnt lgkmcnt(10)
  v_mfma_f32_32x32x16_bf16 v[16:31], v[56:59], v[180:183], v[16:31]
  s_waitcnt lgkmcnt(8)
  v_mfma_f32_32x32x16_bf16 v[32:47], v[60:63], v[180:183], v[32:47]
  s_waitcnt vmcnt(18) lgkmcnt(0)
  s_barrier
  v_mfma_f32_32x32x16_bf16 v[16:31], v[64:67], v[184:187], v[16:31]
  ds_read_b64_tr_b16 v[208:209], v10 offset:57344
  ds_read_b64_tr_b16 v[210:211], v10 offset:58368
  s_lshl_b32 s30, s42, 12
  buffer_load_dwordx4 v[176:179], v9, s[12:15], s30 offen offset:0 sc1
  buffer_load_dwordx4 v[180:183], v9, s[12:15], s30 offen offset:1024 sc1
  s_lshl_b32 s35, s42, 17
  s_add_u32 s35, s35, s29
  s_add_u32 m0, s41, 49152
s_nop 0
  buffer_load_dwordx4 v8, s[8:11], s35 offen  lds
  v_mfma_f32_32x32x16_bf16 v[32:47], v[68:71], v[184:187], v[32:47]
  ds_read_b64_tr_b16 v[212:213], v11 offset:57344
  ds_read_b64_tr_b16 v[214:215], v11 offset:58368
  buffer_load_dwordx4 v[184:187], v9, s[12:15], s30 offen offset:2048 sc1
  v_mfma_f32_32x32x16_bf16 v[16:31], v[72:75], v[188:191], v[16:31]
  ds_read_b64_tr_b16 v[216:217], v10 offset:59392
  ds_read_b64_tr_b16 v[218:219], v10 offset:60416
  v_mfma_f32_32x32x16_bf16 v[32:47], v[76:79], v[188:191], v[32:47]
  ds_read_b64_tr_b16 v[220:221], v11 offset:59392
  ds_read_b64_tr_b16 v[222:223], v11 offset:60416
  buffer_load_dwordx4 v[188:191], v9, s[12:15], s30 offen offset:3072 sc1
  s_add_u32 s35, s35, 16384
  s_add_u32 m0, s41, 50176
s_nop 0
  buffer_load_dwordx4 v8, s[8:11], s35 offen  lds
  s_add_u32 s43, s43, 1
  s_add_u32 s42, s43, s74
  s_and_b32 s42, s42, 7
  s_and_b32 s36, s43, 248
  s_or_b32 s42, s42, s36
  s_waitcnt lgkmcnt(6)
  v_mfma_f32_32x32x16_bf16 v[16:31], v[208:211], v[192:195], v[16:31]
  ds_read_b64_tr_b16 v[224:225], v10 offset:61440
  ds_read_b64_tr_b16 v[226:227], v10 offset:62464
  ds_read_b64_tr_b16 v[228:229], v11 offset:61440
  ds_read_b64_tr_b16 v[230:231], v11 offset:62464
  s_waitcnt lgkmcnt(8)
  v_mfma_f32_32x32x16_bf16 v[32:47], v[212:215], v[192:195], v[32:47]
  ds_read_b64_tr_b16 v[232:233], v10 offset:63488
  ds_read_b64_tr_b16 v[234:235], v10 offset:64512
  ds_read_b64_tr_b16 v[236:237], v11 offset:63488
  ds_read_b64_tr_b16 v[238:239], v11 offset:64512
  s_waitcnt lgkmcnt(10)
  v_mfma_f32_32x32x16_bf16 v[16:31], v[216:219], v[196:199], v[16:31]
  s_waitcnt lgkmcnt(8)
  v_mfma_f32_32x32x16_bf16 v[32:47], v[220:223], v[196:199], v[32:47]
  s_waitcnt vmcnt(18) lgkmcnt(0)
  s_barrier
  v_mfma_f32_32x32x16_bf16 v[16:31], v[224:227], v[200:203], v[16:31]
  ds_read_b64_tr_b16 v[48:49], v10 offset:0
  ds_read_b64_tr_b16 v[50:51], v10 offset:1024
  s_lshl_b32 s30, s42, 12
  buffer_load_dwordx4 v[192:195], v9, s[12:15], s30 offen offset:0 sc1
  buffer_load_dwordx4 v[196:199], v9, s[12:15], s30 offen offset:1024 sc1
  s_lshl_b32 s35, s42, 17
  s_add_u32 s35, s35, s29
  s_add_u32 m0, s41, 57344
s_nop 0
  buffer_load_dwordx4 v8, s[8:11], s35 offen  lds
  v_mfma_f32_32x32x16_bf16 v[32:47], v[228:231], v[200:203], v[32:47]
  ds_read_b64_tr_b16 v[52:53], v11 offset:0
  ds_read_b64_tr_b16 v[54:55], v11 offset:1024
  buffer_load_dwordx4 v[200:203], v9, s[12:15], s30 offen offset:2048 sc1
  v_mfma_f32_32x32x16_bf16 v[16:31], v[232:235], v[204:207], v[16:31]
  ds_read_b64_tr_b16 v[56:57], v10 offset:2048
  ds_read_b64_tr_b16 v[58:59], v10 offset:3072
  v_mfma_f32_32x32x16_bf16 v[32:47], v[236:239], v[204:207], v[32:47]
  ds_read_b64_tr_b16 v[60:61], v11 offset:2048
  ds_read_b64_tr_b16 v[62:63], v11 offset:3072
  buffer_load_dwordx4 v[204:207], v9, s[12:15], s30 offen offset:3072 sc1
  s_add_u32 s35, s35, 16384
  s_add_u32 m0, s41, 58368
s_nop 0
  buffer_load_dwordx4 v8, s[8:11], s35 offen  lds
  s_add_u32 s43, s43, 1
  s_add_u32 s42, s43, s74
  s_and_b32 s42, s42, 7
  s_and_b32 s36, s43, 248
  s_or_b32 s42, s42, s36
  s_sub_u32 s28, s28, 1
  s_cmp_lg_u32 s28, 0
  s_cbranch_scc1 L_o
  s_waitcnt lgkmcnt(6)
  v_mfma_f32_32x32x16_bf16 v[16:31], v[48:51], v[80:83], v[16:31]
  ds_read_b64_tr_b16 v[64:65], v10 offset:4096
  ds_read_b64_tr_b16 v[66:67], v10 offset:5120
  ds_read_b64_tr_b16 v[68:69], v11 offset:4096
  ds_read_b64_tr_b16 v[70:71], v11 offset:5120
  s_waitcnt lgkmcnt(8)
  v_mfma_f32_32x32x16_bf16 v[32:47], v[52:55], v[80:83], v[32:47]
  ds_read_b64_tr_b16 v[72:73], v10 offset:6144
  ds_read_b64_tr_b16 v[74:75], v10 offset:7168
  ds_read_b64_tr_b16 v[76:77], v11 offset:6144
  ds_read_b64_tr_b16 v[78:79], v11 offset:7168
  s_waitcnt lgkmcnt(10)
  v_mfma_f32_32x32x16_bf16 v[16:31], v[56:59], v[84:87], v[16:31]
  s_waitcnt lgkmcnt(8)
  v_mfma_f32_32x32x16_bf16 v[32:47], v[60:63], v[84:87], v[32:47]
  s_waitcnt vmcnt(36) lgkmcnt(0)
  s_barrier
  v_mfma_f32_32x32x16_bf16 v[16:31], v[64:67], v[88:91], v[16:31]
  ds_read_b64_tr_b16 v[208:209], v10 offset:8192
  ds_read_b64_tr_b16 v[210:211], v10 offset:9216
  v_mfma_f32_32x32x16_bf16 v[32:47], v[68:71], v[88:91], v[32:47]
  ds_read_b64_tr_b16 v[212:213], v11 offset:8192
  ds_read_b64_tr_b16 v[214:215], v11 offset:9216
  v_mfma_f32_32x32x16_bf16 v[16:31], v[72:75], v[92:95], v[16:31]
  ds_read_b64_tr_b16 v[216:217], v10 offset:10240
  ds_read_b64_tr_b16 v[218:219], v10 offset:11264
  v_mfma_f32_32x32x16_bf16 v[32:47], v[76:79], v[92:95], v[32:47]
  ds_read_b64_tr_b16 v[220:221], v11 offset:10240
  ds_read_b64_tr_b16 v[222:223], v11 offset:11264
  s_waitcnt lgkmcnt(6)
  v_mfma_f32_32x32x16_bf16 v[16:31], v[208:211], v[96:99], v[16:31]
  ds_read_b64_tr_b16 v[224:225], v10 offset:12288
  ds_read_b64_tr_b16 v[226:227], v10 offset:13312
  ds_read_b64_tr_b16 v[228:229], v11 offset:12288
  ds_read_b64_tr_b16 v[230:231], v11 offset:13312
  s_waitcnt lgkmcnt(8)
  v_mfma_f32_32x32x16_bf16 v[32:47], v[212:215], v[96:99], v[32:47]
  ds_read_b64_tr_b16 v[232:233], v10 offset:14336
  ds_read_b64_tr_b16 v[234:235], v10 offset:15360
  ds_read_b64_tr_b16 v[236:237], v11 offset:14336
  ds_read_b64_tr_b16 v[238:239], v11 offset:15360
  s_waitcnt lgkmcnt(10)
  v_mfma_f32_32x32x16_bf16 v[16:31], v[216:219], v[100:103], v[16:31]
  s_waitcnt lgkmcnt(8)
  v_mfma_f32_32x32x16_bf16 v[32:47], v[220:223], v[100:103], v[32:47]
  s_waitcnt vmcnt(30) lgkmcnt(0)
  s_barrier
  v_mfma_f32_32x32x16_bf16 v[16:31], v[224:227], v[104:107], v[16:31]
  ds_read_b64_tr_b16 v[48:49], v10 offset:16384
  ds_read_b64_tr_b16 v[50:51], v10 offset:17408
  v_mfma_f32_32x32x16_bf16 v[32:47], v[228:231], v[104:107], v[32:47]
  ds_read_b64_tr_b16 v[52:53], v11 offset:16384
  ds_read_b64_tr_b16 v[54:55], v11 offset:17408
  v_mfma_f32_32x32x16_bf16 v[16:31], v[232:235], v[108:111], v[16:31]
  ds_read_b64_tr_b16 v[56:57], v10 offset:18432
  ds_read_b64_tr_b16 v[58:59], v10 offset:19456
  v_mfma_f32_32x32x16_bf16 v[32:47], v[236:239], v[108:111], v[32:47]
  ds_read_b64_tr_b16 v[60:61], v11 offset:18432
  ds_read_b64_tr_b16 v[62:63], v11 offset:19456
  s_waitcnt lgkmcnt(6)
  v_mfma_f32_32x32x16_bf16 v[16:31], v[48:51], v[112:115], v[16:31]
  ds_read_b64_tr_b16 v[64:65], v10 offset:20480
  ds_read_b64_tr_b16 v[66:67], v10 offset:21504
  ds_read_b64_tr_b16 v[68:69], v11 offset:20480
  ds_read_b64_tr_b16 v[70:71], v11 offset:21504
  s_waitcnt lgkmcnt(8)
  v_mfma_f32_32x32x16_bf16 v[32:47], v[52:55], v[112:115], v[32:47]
  ds_read_b64_tr_b16 v[72:73], v10 offset:22528
  ds_read_b64_tr_b16 v[74:75], v10 offset:23552
  ds_read_b64_tr_b16 v[76:77], v11 offset:22528
  ds_read_b64_tr_b16 v[78:79], v11 offset:23552
  s_waitcnt lgkmcnt(10)
  v_mfma_f32_32x32x16_bf16 v[16:31], v[56:59], v[116:119], v[16:31]
  s_waitcnt lgkmcnt(8)
  v_mfma_f32_32x32x16_bf16 v[32:47], v[60:63], v[116:119], v[32:47]
  s_waitcnt vmcnt(24) lgkmcnt(0)
  s_barrier
  v_mfma_f32_32x32x16_bf16 v[16:31], v[64:67], v[120:123], v[16:31]
  ds_read_b64_tr_b16 v[208:209], v10 offset:24576
  ds_read_b64_tr_b16 v[210:211], v10 offset:25600
  v_mfma_f32_32x32x16_bf16 v[32:47], v[68:71], v[120:123], v[32:47]
  ds_read_b64_tr_b16 v[212:213], v11 offset:24576
  ds_read_b64_tr_b16 v[214:215], v11 offset:25600
  v_mfma_f32_32x32x16_bf16 v[16:31], v[72:75], v[124:127], v[16:31]
  ds_read_b64_tr_b16 v[216:217], v10 offset:26624
  ds_read_b64_tr_b16 v[218:219], v10 offset:27648
  v_mfma_f32_32x32x16_bf16 v[32:47], v[76:79], v[124:127], v[32:47]
  ds_read_b64_tr_b16 v[220:221], v11 offset:26624
  ds_read_b64_tr_b16 v[222:223], v11 offset:27648
  s_waitcnt lgkmcnt(6)
  v_mfma_f32_32x32x16_bf16 v[16:31], v[208:211], v[128:131], v[16:31]
  ds_read_b64_tr_b16 v[224:225], v10 offset:28672
  ds_read_b64_tr_b16 v[226:227], v10 offset:29696
  ds_read_b64_tr_b16 v[228:229], v11 offset:28672
  ds_read_b64_tr_b16 v[230:231], v11 offset:29696
  s_waitcnt lgkmcnt(8)
  v_mfma_f32_32x32x16_bf16 v[32:47], v[212:215], v[128:131], v[32:47]
  ds_read_b64_tr_b16 v[232:233], v10 offset:30720
  ds_read_b64_tr_b16 v[234:235], v10 offset:31744
  ds_read_b64_tr_b16 v[236:237], v11 offset:30720
  ds_read_b64_tr_b16 v[238:239], v11 offset:31744
  s_waitcnt lgkmcnt(10)
  v_mfma_f32_32x32x16_bf16 v[16:31], v[216:219], v[132:135], v[16:31]
  s_waitcnt lgkmcnt(8)
  v_mfma_f32_32x32x16_bf16 v[32:47], v[220:223], v[132:135], v[32:47]
  s_waitcnt vmcnt(18) lgkmcnt(0)
  s_barrier
  v_mfma_f32_32x32x16_bf16 v[16:31], v[224:227], v[136:139], v[16:31]
  ds_read_b64_tr_b16 v[48:49], v10 offset:32768
  ds_read_b64_tr_b16 v[50:51], v10 offset:33792
  v_mfma_f32_32x32x16_bf16 v[32:47], v[228:231], v[136:139], v[32:47]
  ds_read_b64_tr_b16 v[52:53], v11 offset:32768
  ds_read_b64_tr_b16 v[54:55], v11 offset:33792
  v_mfma_f32_32x32x16_bf16 v[16:31], v[232:235], v[140:143], v[16:31]
  ds_read_b64_tr_b16 v[56:57], v10 offset:34816
  ds_read_b64_tr_b16 v[58:59], v10 offset:35840
  v_mfma_f32_32x32x16_bf16 v[32:47], v[236:239], v[140:143], v[32:47]
  ds_read_b64_tr_b16 v[60:61], v11 offset:34816
  ds_read_b64_tr_b16 v[62:63], v11 offset:35840
  s_waitcnt lgkmcnt(6)
  v_mfma_f32_32x32x16_bf16 v[16:31], v[48:51], v[144:147], v[16:31]
  ds_read_b64_tr_b16 v[64:65], v10 offset:36864
  ds_read_b64_tr_b16 v[66:67], v10 offset:37888
  ds_read_b64_tr_b16 v[68:69], v11 offset:36864
  ds_read_b64_tr_b16 v[70:71], v11 offset:37888
  s_waitcnt lgkmcnt(8)
  v_mfma_f32_32x32x16_bf16 v[32:47], v[52:55], v[144:147], v[32:47]
  ds_read_b64_tr_b16 v[72:73], v10 offset:38912
  ds_read_b64_tr_b16 v[74:75], v10 offset:39936
  ds_read_b64_tr_b16 v[76:77], v11 offset:38912
  ds_read_b64_tr_b16 v[78:79], v11 offset:39936
  s_waitcnt lgkmcnt(10)
  v_mfma_f32_32x32x16_bf16 v[16:31], v[56:59], v[148:151], v[16:31]
  s_waitcnt lgkmcnt(8)
  v_mfma_f32_32x32x16_bf16 v[32:47], v[60:63], v[148:151], v[32:47]
  s_waitcnt vmcnt(12) lgkmcnt(0)
  s_barrier
  v_mfma_f32_32x32x16_bf16 v[16:31], v[64:67], v[152:155], v[16:31]
  ds_read_b64_tr_b16 v[208:209], v10 offset:40960
  ds_read_b64_tr_b16 v[210:211], v10 offset:41984
  v_mfma_f32_32x32x16_bf16 v[32:47], v[68:71], v[152:155], v[32:47]
  ds_read_b64_tr_b16 v[212:213], v11 offset:40960
  ds_read_b64_tr_b16 v[214:215], v11 offset:41984
  v_mfma_f32_32x32x16_bf16 v[16:31], v[72:75], v[156:159], v[16:31]
  ds_read_b64_tr_b16 v[216:217], v10 offset:43008
  ds_read_b64_tr_b16 v[218:219], v10 offset:44032
  v_mfma_f32_32x32x16_bf16 v[32:47], v[76:79], v[156:159], v[32:47]
  ds_read_b64_tr_b16 v[220:221], v11 offset:43008
  ds_read_b64_tr_b16 v[222:223], v11 offset:44032
  s_waitcnt lgkmcnt(6)
  v_mfma_f32_32x32x16_bf16 v[16:31], v[208:211], v[160:163], v[16:31]
  ds_read_b64_tr_b16 v[224:225], v10 offset:45056
  ds_read_b64_tr_b16 v[226:227], v10 offset:46080
  ds_read_b64_tr_b16 v[228:229], v11 offset:45056
  ds_read_b64_tr_b16 v[230:231], v11 offset:46080
  s_waitcnt lgkmcnt(8)
  v_mfma_f32_32x32x16_bf16 v[32:47], v[212:215], v[160:163], v[32:47]
  ds_read_b64_tr_b16 v[232:233], v10 offset:47104
  ds_read_b64_tr_b16 v[234:235], v10 offset:48128
  ds_read_b64_tr_b16 v[236:237], v11 offset:47104
  ds_read_b64_tr_b16 v[238:239], v11 offset:48128
  s_waitcnt lgkmcnt(10)
  v_mfma_f32_32x32x16_bf16 v[16:31], v[216:219], v[164:167], v[16:31]
  s_waitcnt lgkmcnt(8)
  v_mfma_f32_32x32x16_bf16 v[32:47], v[220:223], v[164:167], v[32:47]
  s_waitcnt vmcnt(6) lgkmcnt(0)
  s_barrier
  v_mfma_f32_32x32x16_bf16 v[16:31], v[224:227], v[168:171], v[16:31]
  ds_read_b64_tr_b16 v[48:49], v10 offset:49152
  ds_read_b64_tr_b16 v[50:51], v10 offset:50176
  v_mfma_f32_32x32x16_bf16 v[32:47], v[228:231], v[168:171], v[32:47]
  ds_read_b64_tr_b16 v[52:53], v11 offset:49152
  ds_read_b64_tr_b16 v[54:55], v11 offset:50176
  v_mfma_f32_32x32x16_bf16 v[16:31], v[232:235], v[172:175], v[16:31]
  ds_read_b64_tr_b16 v[56:57], v10 offset:51200
  ds_read_b64_tr_b16 v[58:59], v10 offset:52224
  v_mfma_f32_32x32x16_bf16 v[32:47], v[236:239], v[172:175], v[32:47]
  ds_read_b64_tr_b16 v[60:61], v11 offset:51200
  ds_read_b64_tr_b16 v[62:63], v11 offset:52224
  s_waitcnt lgkmcnt(6)
  v_mfma_f32_32x32x16_bf16 v[16:31], v[48:51], v[176:179], v[16:31]
  ds_read_b64_tr_b16 v[64:65], v10 offset:53248
  ds_read_b64_tr_b16 v[66:67], v10 offset:54272
  ds_read_b64_tr_b16 v[68:69], v11 offset:53248
  ds_read_b64_tr_b16 v[70:71], v11 offset:54272
  s_waitcnt lgkmcnt(8)
  v_mfma_f32_32x32x16_bf16 v[32:47], v[52:55], v[176:179], v[32:47]
  ds_read_b64_tr_b16 v[72:73], v10 offset:55296
  ds_read_b64_tr_b16 v[74:75], v10 offset:56320
  ds_read_b64_tr_b16 v[76:77], v11 offset:55296
  ds_read_b64_tr_b16 v[78:79], v11 offset:56320
  s_waitcnt lgkmcnt(10)
  v_mfma_f32_32x32x16_bf16 v[16:31], v[56:59], v[180:183], v[16:31]
  s_waitcnt lgkmcnt(8)
  v_mfma_f32_32x32x16_bf16 v[32:47], v[60:63], v[180:183], v[32:47]
  s_waitcnt vmcnt(0) lgkmcnt(0)
  s_barrier
  v_mfma_f32_32x32x16_bf16 v[16:31], v[64:67], v[184:187], v[16:31]
  ds_read_b64_tr_b16 v[208:209], v10 offset:57344
  ds_read_b64_tr_b16 v[210:211], v10 offset:58368
  v_mfma_f32_32x32x16_bf16 v[32:47], v[68:71], v[184:187], v[32:47]
  ds_read_b64_tr_b16 v[212:213], v11 offset:57344
  ds_read_b64_tr_b16 v[214:215], v11 offset:58368
  v_mfma_f32_32x32x16_bf16 v[16:31], v[72:75], v[188:191], v[16:31]
  ds_read_b64_tr_b16 v[216:217], v10 offset:59392
  ds_read_b64_tr_b16 v[218:219], v10 offset:60416
  v_mfma_f32_32x32x16_bf16 v[32:47], v[76:79], v[188:191], v[32:47]
  ds_read_b64_tr_b16 v[220:221], v11 offset:59392
  ds_read_b64_tr_b16 v[222:223], v11 offset:60416
  s_waitcnt lgkmcnt(6)
  v_mfma_f32_32x32x16_bf16 v[16:31], v[208:211], v[192:195], v[16:31]
  ds_read_b64_tr_b16 v[224:225], v10 offset:61440
  ds_read_b64_tr_b16 v[226:227], v10 offset:62464
  ds_read_b64_tr_b16 v[228:229], v11 offset:61440
  ds_read_b64_tr_b16 v[230:231], v11 offset:62464
  s_waitcnt lgkmcnt(8)
  v_mfma_f32_32x32x16_bf16 v[32:47], v[212:215], v[192:195], v[32:47]
  ds_read_b64_tr_b16 v[232:233], v10 offset:63488
  ds_read_b64_tr_b16 v[234:235], v10 offset:64512
  ds_read_b64_tr_b16 v[236:237], v11 offset:63488
  ds_read_b64_tr_b16 v[238:239], v11 offset:64512
  s_waitcnt lgkmcnt(10)
  v_mfma_f32_32x32x16_bf16 v[16:31], v[216:219], v[196:199], v[16:31]
  s_waitcnt lgkmcnt(8)
  v_mfma_f32_32x32x16_bf16 v[32:47], v[220:223], v[196:199], v[32:47]
  s_waitcnt lgkmcnt(0)
  v_mfma_f32_32x32x16_bf16 v[16:31], v[224:227], v[200:203], v[16:31]
  v_mfma_f32_32x32x16_bf16 v[32:47], v[228:231], v[200:203], v[32:47]
  v_mfma_f32_32x32x16_bf16 v[16:31], v[232:235], v[204:207], v[16:31]
  v_mfma_f32_32x32x16_bf16 v[32:47], v[236:239], v[204:207], v[32:47]
s_nop 10
  v_cvt_pk_bf16_f32 v48, v16, v17
  v_cvt_pk_bf16_f32 v49, v18, v19
  v_cvt_pk_bf16_f32 v50, v20, v21
  v_cvt_pk_bf16_f32 v51, v22, v23
  v_cvt_pk_bf16_f32 v52, v24, v25
  v_cvt_pk_bf16_f32 v53, v26, v27
  v_cvt_pk_bf16_f32 v54, v28, v29
  v_cvt_pk_bf16_f32 v55, v30, v31
  v_cvt_pk_bf16_f32 v56, v32, v33
  v_cvt_pk_bf16_f32 v57, v34, v35
  v_cvt_pk_bf16_f32 v58, v36, v37
  v_cvt_pk_bf16_f32 v59, v38, v39
  v_cvt_pk_bf16_f32 v60, v40, v41
  v_cvt_pk_bf16_f32 v61, v42, v43
  v_cvt_pk_bf16_f32 v62, v44, v45
  v_cvt_pk_bf16_f32 v63, v46, v47
  v_and_b32 v1, 31, v0
  v_lshlrev_b32 v1, 12, v1
  v_lshrrev_b32 v2, 5, v0
  v_lshl_add_u32 v1, v2, 4, v1
  buffer_store_dwordx4 v[48:51], v1, s[16:19], 0 offen offset:0
  buffer_store_dwordx4 v[52:55], v1, s[16:19], 0 offen offset:32
  buffer_store_dwordx4 v[56:59], v1, s[16:19], 0 offen offset:64
  buffer_store_dwordx4 v[60:63], v1, s[16:19], 0 offen offset:96
L_qa_end:
  s_endpgm
.section .rodata,"a"
.p2align 6
.amdhsa_kernel concat_heads__gqa_block_cached__mha_block_cached__near_ridge_kernel
  .amdhsa_next_free_vgpr 256
  .amdhsa_next_free_sgpr 102
  .amdhsa_accum_offset 256
  .amdhsa_group_segment_fixed_size 0
  .amdhsa_kernarg_size 104
  .amdhsa_user_sgpr_count 2
  .amdhsa_user_sgpr_kernarg_segment_ptr 1
  .amdhsa_system_sgpr_workgroup_id_x 1
.end_amdhsa_kernel
```
